```python
import torch

def _softmax(x, axis=-1):
    return torch.softmax(x, dim=axis)
def _gelu(x):
    return torch.nn.functional.gelu(x, approximate="tanh")
def _silu(x):
    return torch.nn.functional.silu(x)
def _sigmoid(x):
    return torch.sigmoid(x)
def _layernorm(x, axis=-1, eps=1e-5):
    m = x.mean(dim=axis, keepdim=True)
    v = x.var(dim=axis, keepdim=True, unbiased=False)
    return (x - m) / torch.sqrt(v + eps)
def _scatter_add(tgt, idx, src, axis=0):
    return tgt.clone().index_add_(axis, idx, src)
def _segment_sum(src, seg, n):
    out = torch.zeros((n,) + src.shape[1:], dtype=src.dtype)
    return out.index_add_(0, seg, src)
def _pad(x, pw):
    flat = tuple(v for pair in reversed(pw) for v in pair)
    return torch.nn.functional.pad(x, flat)

kernel_name = 'sequential_preLN__sliding_block_cached__swiglu_ffn__decode'

def setup_inputs():

    _w = (lambda a: (lambda t: t.to(torch.bfloat16) if t.is_floating_point() else t)(torch.as_tensor(a)))
    def _A_setup():
        B, Sq, D = 2, 1, 512
        Hq, Hkv, Sk, Dh = 32, 8, 32768, 128
        assert Hq % Hkv == 0, (Hq, Hkv)
        return {
            "x": _w((lambda *s: torch.randn(*s, dtype=torch.bfloat16) * 0.05)(B, Sq, D)),
            "k_cache": _w((lambda *s: torch.randn(*s, dtype=torch.bfloat16) * 3.2)(B, Hkv, Sk, Dh)),
            "v_cache": _w((lambda *s: torch.randn(*s, dtype=torch.bfloat16) * 0.4)(B, Hkv, Sk, Dh)),
            "wq": _w((lambda *s: torch.randn(*s, dtype=torch.bfloat16) * 3.2)(D, Hq * Dh) * (D ** -0.5)),
            "wo": _w((lambda *s: torch.randn(*s, dtype=torch.bfloat16) * 0.4)(Hq * Dh, D) * ((Hq * Dh) ** -0.5)),
        }
    _A_in = _A_setup()

    def _B_setup():
        B, S, D, F = 2, 1, 512, 1792
        return {
            "x": _w((lambda *s: torch.randn(*s, dtype=torch.bfloat16) * 0.05)(B, S, D)),
            "w_gate": _w((lambda *s: torch.randn(*s, dtype=torch.bfloat16) * 0.05)(D, F)),
            "w_up": _w((lambda *s: torch.randn(*s, dtype=torch.bfloat16) * 0.05)(D, F)),
            "w_down": _w((lambda *s: torch.randn(*s, dtype=torch.bfloat16) * 0.05)(F, D)),
        }
    _B_in = _B_setup()

    return {
        "A_x": _A_in["x"],
        "A_k_cache": _A_in["k_cache"],
        "A_v_cache": _A_in["v_cache"],
        "A_wq": _A_in["wq"],
        "A_wo": _A_in["wo"],
        "B_x": _B_in["x"],
        "B_w_gate": _B_in["w_gate"],
        "B_w_up": _B_in["w_up"],
        "B_w_down": _B_in["w_down"],
    }

def reference(A_x, A_k_cache, A_v_cache, A_wq, A_wo, B_x, B_w_gate, B_w_up, B_w_down):
    def _A_ref(x, k_cache, v_cache, wq, wo):
        B, Sq, D = x.shape
        Hq, Dh = 32, 128
        Hkv, Sk = k_cache.shape[1], k_cache.shape[2]
        W = min(4096, max(256, Sk // 4))
        rep = Hq // Hkv
        q = (lambda x, *d: x.permute(*d))((x @ wq).reshape(B, Sq, Hq, Dh), 0, 2, 1, 3)
        k = (lambda x, n, axis: torch.repeat_interleave(x, n, dim=axis))(k_cache[:, :, Sk - W:, :], rep, axis=1)
        v = (lambda x, n, axis: torch.repeat_interleave(x, n, dim=axis))(v_cache[:, :, Sk - W:, :], rep, axis=1)
        scores = torch.einsum("bhqd,bhkd->bhqk", q, k) * (Dh ** -0.5)
        p = _softmax(scores, axis=-1)
        o = torch.einsum("bhqk,bhkd->bhqd", p, v)
        return (lambda x, *d: x.permute(*d))(o, 0, 2, 1, 3).reshape(B, Sq, Hq * Dh) @ wo

    def _B_ref(x, w_gate, w_up, w_down):
        g = _silu(x @ w_gate)
        u = x @ w_up
        return (g * u) @ w_down

    x = A_x
    h = x + _A_ref(_layernorm(x, axis=-1), A_k_cache, A_v_cache, A_wq, A_wo)
    h2 = h + _B_ref(_layernorm(h, axis=-1), B_w_gate, B_w_up, B_w_down)
    return h2
```

```asm
; @launch grid=(256,1,1) block=(576,1,1) lds=133120
.amdgcn_target "amdgcn-amd-amdhsa--gfx950"
.text
.globl sequential_preLN__sliding_block_cached__swiglu_ffn__decode_kernel
.p2align 8
.type sequential_preLN__sliding_block_cached__swiglu_ffn__decode_kernel,@function
sequential_preLN__sliding_block_cached__swiglu_ffn__decode_kernel:
  s_cmp_ge_u32 s2, 256
  s_cbranch_scc1 L_exit
  s_load_dwordx16 s[4:19], s[0:1], 0
  s_load_dwordx8 s[20:27], s[0:1], 64
  v_lshrrev_b32 v1, 6, v0
  v_and_b32 v0, 63, v0
  v_readfirstlane_b32 s46, v1
  s_and_b32 s44, s2, 7
  s_lshr_b32 s45, s2, 3
  s_lshr_b32 s57, s45, 4
  s_lshr_b32 s58, s45, 3
  s_bfe_u32 s59, s45, 0x10002
  s_and_b32 s60, s45, 3
  s_mov_b32 s64, 0x7060500
  s_mov_b32 s65, 0x7060501
  s_mov_b32 s66, 0x7060502
  s_mov_b32 s67, 0x7060503
  s_mov_b32 s61, 0x0c0c0400
  s_mov_b32 s62, 0x04000c0c
  s_mov_b32 s76, 0x05040100
  s_mov_b32 s77, 0x07060302
  s_cmp_eq_u32 s46, 0
  s_cbranch_scc1 L_control
  s_setprio 2
  s_sub_u32 s47, s46, 1
  v_lshrrev_b32 v8, 3, v0
  v_bfe_u32 v9, v0, 4, 1
  v_bfe_u32 v10, v0, 1, 2
  v_and_b32 v11, 1, v0
  v_lshlrev_b32 v11, 4, v11
  v_lshl_add_u32 v11, v8, 13, v11
  v_xor_b32 v12, v9, v10
  v_lshl_add_u32 v14, v12, 5, v11
  s_lshr_b32 s50, s45, 3
  s_lshl_b32 s50, s50, 20
  s_lshl_b32 s51, s44, 10
  s_add_u32 s50, s50, s51
  s_and_b32 s51, s45, 7
  s_lshl_b32 s51, s51, 7
  s_add_u32 s50, s50, s51
  s_lshl_b32 s51, s47, 17
  s_lshl_b32 s52, s47, 11
  s_waitcnt lgkmcnt(0)
  s_add_u32 s40, s10, s50
  s_addc_u32 s41, s11, 0
  s_and_b32 s41, s41, 0xffff
  s_mov_b32 s42, 1040512
  s_mov_b32 s43, 0x20000
  s_add_u32 m0, s52, 0
  s_nop 0
  buffer_load_dwordx4 v14, s[40:43], s51 offen nt lds
  v_xor_b32 v12, 2, v12
  v_lshl_add_u32 v15, v12, 5, v11
  s_add_u32 m0, s52, 1024
  s_add_u32 s51, s51, 65536
  s_and_b32 s52, s45, 15
  s_lshl_b32 s49, s57, 3
  s_add_u32 s49, s49, s44
  s_lshl_b32 s49, s49, 23
  s_lshl_b32 s50, s52, 16
  s_add_u32 s49, s49, s50
  s_add_u32 s49, s49, 7340032
  s_add_u32 s28, s6, s49
  s_addc_u32 s29, s7, 0
  s_and_b32 s29, s29, 0xffff
  s_mov_b32 s30, 65536
  s_mov_b32 s31, 0x20000
  s_barrier
  buffer_load_dwordx4 v15, s[40:43], s51 offen nt lds
  s_add_u32 s32, s8, s49
  s_addc_u32 s33, s9, 0
  s_and_b32 s33, s33, 0xffff
  s_mov_b32 s34, 65536
  s_mov_b32 s35, 0x20000
  s_mov_b32 s36, s26
  s_and_b32 s37, s27, 0xffff
  s_mov_b32 s38, 4194304
  s_mov_b32 s39, 0x20000
  s_lshl_b32 s50, s52, 2
  s_lshr_b32 s51, s44, 1
  s_add_u32 s50, s50, s51
  s_and_b32 s48, s50, 7
  s_lshr_b32 s50, s50, 3
  s_add_u32 s50, s50, s47
  s_and_b32 s50, s50, 7
  s_lshl_b32 s50, s50, 13
  v_lshrrev_b32 v10, 4, v0
  v_and_b32 v11, 15, v0
  v_lshl_add_u32 v12, v10, 8, s50
  v_lshlrev_b32 v10, 2, v10
  v_xor_b32 v11, v10, v11
  v_xor_b32 v13, 0, v11
  v_lshl_add_u32 v140, v13, 4, v12
  v_xor_b32 v13, 1, v11
  v_lshl_add_u32 v141, v13, 4, v12
  v_xor_b32 v13, 2, v11
  v_lshl_add_u32 v142, v13, 4, v12
  v_xor_b32 v13, 3, v11
  v_lshl_add_u32 v143, v13, 4, v12
  s_mul_i32 s3, s47, 12288
  s_add_u32 s3, s3, 18432
  v_lshrrev_b32 v10, 4, v0
  v_and_b32 v11, 1, v10
  v_lshlrev_b32 v11, 2, v11
  v_bfe_u32 v13, v0, 1, 3
  v_xor_b32 v11, v11, v13
  v_and_b32 v13, 1, v0
  v_lshl_add_u32 v12, v13, 4, v12
  v_xor_b32 v13, 0, v11
  v_lshl_add_u32 v144, v13, 5, v12
  v_xor_b32 v13, 1, v11
  v_lshl_add_u32 v145, v13, 5, v12
  v_xor_b32 v13, 2, v11
  v_lshl_add_u32 v146, v13, 5, v12
  v_xor_b32 v13, 3, v11
  v_lshl_add_u32 v147, v13, 5, v12
  s_barrier
  s_add_u32 s49, s48, 0
  s_and_b32 s49, s49, 7
  s_lshl_b32 s49, s49, 10
  s_add_u32 m0, s3, 0
  s_nop 0
  buffer_load_dwordx4 v140, s[28:31], s49 offen nt lds
  v_lshrrev_b32 v8, 4, v0
  v_and_b32 v9, 3, v0
  v_mul_u32_u24 v10, 320, v9
  v_lshl_add_u32 v10, v8, 4, v10
  v_add_u32 v152, 118784, v10
  s_lshl_b32 s49, s47, 2
  s_add_u32 s49, s49, 123776
  v_lshl_add_u32 v153, v9, 5, s49
  v_mul_u32_u24 v10, 33, v9
  v_add_u32 v10, v10, v8
  v_bfe_u32 v11, v0, 2, 2
  v_lshl_add_u32 v10, v11, 2, v10
  s_mul_i32 s49, s47, 2112
  s_add_u32 s49, s49, 0
  v_lshl_add_u32 v154, v10, 4, s49
  s_lshl_b32 s49, s47, 6
  v_add_u32 v10, s49, v0
  v_lshrrev_b32 v12, 5, v10
  v_lshlrev_b32 v156, 5, v12
  v_add_u32 v156, 124032, v156
  v_add_u32 v12, v12, v10
  v_lshlrev_b32 v12, 4, v12
  v_add_u32 v155, 0, v12
  v_lshlrev_b32 v157, 4, v0
  s_lshl_b32 s49, s44, 5
  s_add_u32 s49, s49, s45
  s_lshl_b32 s49, s49, 11
  s_lshl_b32 s50, s47, 10
  s_add_u32 s49, s49, s50
  s_add_u32 s6, s49, 524288
  v_mov_b32 v4, 0
  v_mov_b32 v5, 0
  v_mov_b32 v158, 0
  v_mov_b32 v159, 0
  s_cmp_lt_u32 s45, 14
  s_cbranch_scc1 L_suf_1
  s_cmp_ge_u32 s45, 30
  s_cbranch_scc1 L_sui_2
  s_sub_u32 s63, s45, 14
  s_lshr_b32 s58, s63, 2
  s_bfe_u32 s59, s63, 0x10001
  s_and_b32 s60, s63, 1
  s_lshl_b32 s49, s44, 2
  s_add_u32 s49, s49, s58
  s_lshl_b32 s49, s49, 1
  s_add_u32 s49, s49, s59
  s_lshl_b32 s49, s49, 16
  s_lshl_b32 s50, s60, 9
  s_add_u32 s49, s49, s50
  s_add_u32 s40, s12, s49
  s_addc_u32 s41, s13, 0
  s_and_b32 s41, s41, 0xffff
  s_mov_b32 s42, 65024
  s_mov_b32 s43, 0x20000
  v_lshrrev_b32 v10, 5, v0
  s_and_b32 s50, s47, 1
  s_lshl_b32 s51, s50, 2
  v_or_b32 v12, s51, v10
  v_bfe_u32 v13, v0, 1, 4
  v_and_b32 v14, 1, v0
  v_lshlrev_b32 v14, 4, v14
  v_lshl_add_u32 v14, v10, 10, v14
  v_xor_b32 v15, v12, v13
  v_lshl_add_u32 v4, v15, 5, v14
  v_xor_b32 v15, 2, v15
  v_lshl_add_u32 v5, v15, 5, v14
  s_lshl_b32 s15, s47, 13
  v_lshrrev_b32 v10, 2, v0
  v_lshlrev_b32 v12, 4, v9
  v_lshl_add_u32 v158, v10, 11, v12
  s_lshr_b32 s51, s47, 2
  s_lshl_b32 s49, s44, 16
  s_lshl_b32 s50, s51, 15
  s_add_u32 s49, s49, s50
  s_lshl_b32 s50, s58, 9
  s_add_u32 s49, s49, s50
  s_lshl_b32 s50, s59, 8
  s_add_u32 s49, s49, s50
  s_and_b32 s50, s47, 3
  s_lshl_b32 s50, s50, 6
  s_add_u32 s49, s49, s50
  s_add_u32 s7, s49, 524288
  s_lshl_b32 s51, s51, 6
  s_add_u32 s51, s51, 122944
  v_lshl_add_u32 v159, v10, 2, s51
  s_branch L_sue_3
L_suf_1:
  s_mul_i32 s50, s44, 448
  s_lshl_b32 s51, s45, 5
  s_add_u32 s14, s50, s51
  s_lshl_b32 s50, s14, 9
  s_add_u32 s40, s20, s50
  s_addc_u32 s41, s21, 0
  s_and_b32 s41, s41, 0xffff
  s_mov_b32 s42, 16384
  s_mov_b32 s43, 0x20000
  v_lshrrev_b32 v10, 3, v0
  v_bfe_u32 v14, v0, 4, 2
  v_bfe_u32 v15, v0, 1, 2
  v_xor_b32 v14, v14, v15
  v_lshlrev_b32 v14, 5, v14
  v_and_b32 v12, 1, v0
  v_lshl_add_u32 v14, v12, 4, v14
  v_lshl_add_u32 v4, v10, 10, v14
  s_branch L_sue_3
L_sui_2:
  s_mov_b32 s40, s4
  s_and_b32 s41, s5, 0xffff
  s_mov_b32 s42, 2048
  s_mov_b32 s43, 0x20000
L_sue_3:
  s_waitcnt vmcnt(2)
  s_add_u32 s49, s48, 1
  s_and_b32 s49, s49, 7
  s_lshl_b32 s49, s49, 10
  s_add_u32 m0, s3, 1024
  s_nop 0
  buffer_load_dwordx4 v141, s[28:31], s49 offen nt lds
  s_waitcnt vmcnt(2)
  v_mov_b32 v8, 122916
  v_mov_b32 v9, 1
  s_mov_b64 exec, 1
  ds_add_u32 v8, v9
  s_mov_b64 exec, -1
  s_add_u32 s49, s48, 2
  s_and_b32 s49, s49, 7
  s_lshl_b32 s49, s49, 10
  s_add_u32 m0, s3, 2048
  s_nop 0
  buffer_load_dwordx4 v142, s[28:31], s49 offen nt lds
  s_waitcnt vmcnt(2)
  s_add_u32 s49, s48, 3
  s_and_b32 s49, s49, 7
  s_lshl_b32 s49, s49, 10
  s_add_u32 m0, s3, 3072
  s_nop 0
  buffer_load_dwordx4 v143, s[28:31], s49 offen nt lds
  s_waitcnt vmcnt(2)
  s_add_u32 s49, s48, 4
  s_and_b32 s49, s49, 7
  s_lshl_b32 s49, s49, 10
  s_add_u32 m0, s3, 4096
  s_nop 0
  buffer_load_dwordx4 v140, s[28:31], s49 offen nt lds
  s_waitcnt vmcnt(2)
  s_add_u32 s49, s48, 5
  s_and_b32 s49, s49, 7
  s_lshl_b32 s49, s49, 10
  s_add_u32 m0, s3, 5120
  s_nop 0
  buffer_load_dwordx4 v141, s[28:31], s49 offen nt lds
  s_waitcnt vmcnt(2)
  s_add_u32 s49, s48, 6
  s_and_b32 s49, s49, 7
  s_lshl_b32 s49, s49, 10
  s_add_u32 m0, s3, 6144
  s_nop 0
  buffer_load_dwordx4 v142, s[28:31], s49 offen nt lds
  s_waitcnt vmcnt(2)
  s_add_u32 s49, s48, 7
  s_and_b32 s49, s49, 7
  s_lshl_b32 s49, s49, 10
  s_add_u32 m0, s3, 7168
  s_nop 0
  buffer_load_dwordx4 v143, s[28:31], s49 offen nt lds
  s_waitcnt vmcnt(2)
  s_add_u32 s49, s48, 0
  s_and_b32 s49, s49, 7
  s_lshl_b32 s49, s49, 10
  s_add_u32 m0, s3, 8192
  s_nop 0
  buffer_load_dwordx4 v144, s[32:35], s49 offen nt lds
  s_waitcnt vmcnt(2)
  s_add_u32 s49, s48, 1
  s_and_b32 s49, s49, 7
  s_lshl_b32 s49, s49, 10
  s_add_u32 m0, s3, 9216
  s_nop 0
  buffer_load_dwordx4 v145, s[32:35], s49 offen nt lds
  s_waitcnt vmcnt(3)
  s_add_u32 s49, s48, 2
  s_and_b32 s49, s49, 7
  s_lshl_b32 s49, s49, 10
  s_add_u32 m0, s3, 10240
  s_nop 0
  buffer_load_dwordx4 v146, s[32:35], s49 offen nt lds
  s_waitcnt vmcnt(3)
  s_add_u32 s49, s48, 3
  s_and_b32 s49, s49, 7
  s_lshl_b32 s49, s49, 10
  s_add_u32 m0, s3, 11264
  s_nop 0
  buffer_load_dwordx4 v147, s[32:35], s49 offen nt lds
  v_and_b32 v8, 15, v0
  v_and_b32 v9, 3, v0
  v_bfe_u32 v10, v0, 2, 2
  v_lshlrev_b32 v9, 10, v9
  v_lshl_add_u32 v9, v10, 8, v9
  v_add_u32 v9, s3, v9
  v_lshrrev_b32 v10, 4, v0
  v_xor_b32 v10, v10, v8
  v_xor_b32 v11, 0, v10
  v_lshl_add_u32 v11, v11, 4, v9
  ds_read_b128 v[16:19], v11 offset:0
  ds_read_b128 v[32:35], v11 offset:4096
  v_xor_b32 v11, 4, v10
  v_lshl_add_u32 v11, v11, 4, v9
  ds_read_b128 v[20:23], v11 offset:0
  ds_read_b128 v[36:39], v11 offset:4096
  v_xor_b32 v11, 8, v10
  v_lshl_add_u32 v11, v11, 4, v9
  ds_read_b128 v[24:27], v11 offset:0
  ds_read_b128 v[40:43], v11 offset:4096
  v_xor_b32 v11, 12, v10
  v_lshl_add_u32 v11, v11, 4, v9
  ds_read_b128 v[28:31], v11 offset:0
  ds_read_b128 v[44:47], v11 offset:4096
  s_waitcnt lgkmcnt(0)
  s_waitcnt vmcnt(3)
  s_add_u32 s49, s48, 4
  s_and_b32 s49, s49, 7
  s_lshl_b32 s49, s49, 10
  s_add_u32 m0, s3, 0
  s_nop 0
  buffer_load_dwordx4 v144, s[32:35], s49 offen nt lds
  s_waitcnt vmcnt(3)
  s_add_u32 s49, s48, 5
  s_and_b32 s49, s49, 7
  s_lshl_b32 s49, s49, 10
  s_add_u32 m0, s3, 1024
  s_nop 0
  buffer_load_dwordx4 v145, s[32:35], s49 offen nt lds
  s_waitcnt vmcnt(3)
  s_add_u32 s49, s48, 6
  s_and_b32 s49, s49, 7
  s_lshl_b32 s49, s49, 10
  s_add_u32 m0, s3, 2048
  s_nop 0
  buffer_load_dwordx4 v146, s[32:35], s49 offen nt lds
  s_waitcnt vmcnt(3)
  s_add_u32 s49, s48, 7
  s_and_b32 s49, s49, 7
  s_lshl_b32 s49, s49, 10
  s_add_u32 m0, s3, 3072
  s_nop 0
  buffer_load_dwordx4 v147, s[32:35], s49 offen nt lds
  v_lshrrev_b32 v8, 4, v0
  v_bfe_u32 v9, v0, 2, 2
  v_and_b32 v10, 1, v8
  v_lshl_add_u32 v10, v10, 2, v9
  v_lshlrev_b32 v9, 10, v9
  v_lshl_add_u32 v9, v8, 8, v9
  v_and_b32 v11, 3, v0
  v_lshl_add_u32 v9, v11, 3, v9
  v_add_u32 v9, s3, v9
  v_xor_b32 v11, 0, v10
  v_lshl_add_u32 v48, v11, 5, v9
  v_xor_b32 v11, 1, v10
  v_lshl_add_u32 v49, v11, 5, v9
  v_xor_b32 v11, 2, v10
  v_lshl_add_u32 v50, v11, 5, v9
  v_xor_b32 v11, 3, v10
  v_lshl_add_u32 v51, v11, 5, v9
  v_xor_b32 v11, 4, v10
  v_lshl_add_u32 v52, v11, 5, v9
  v_xor_b32 v11, 5, v10
  v_lshl_add_u32 v53, v11, 5, v9
  v_xor_b32 v11, 6, v10
  v_lshl_add_u32 v54, v11, 5, v9
  v_xor_b32 v11, 7, v10
  v_lshl_add_u32 v55, v11, 5, v9
  ds_read_b64_tr_b16 v[80:81], v48 offset:8192
  ds_read_b64_tr_b16 v[96:97], v52 offset:8192
  ds_read_b64_tr_b16 v[84:85], v49 offset:8192
  ds_read_b64_tr_b16 v[100:101], v53 offset:8192
  ds_read_b64_tr_b16 v[88:89], v50 offset:8192
  ds_read_b64_tr_b16 v[104:105], v54 offset:8192
  ds_read_b64_tr_b16 v[92:93], v51 offset:8192
  ds_read_b64_tr_b16 v[108:109], v55 offset:8192
  s_mov_b32 s68, 0xf000f
  s_mov_b32 s69, 0xf000f
  s_mov_b32 s70, 0xf000f0
  s_mov_b32 s71, 0xf000f0
  s_mov_b32 s72, 0xf000f00
  s_mov_b32 s73, 0xf000f00
  s_mov_b32 s74, 0xf000f000
  s_mov_b32 s75, 0xf000f000
  s_mov_b32 s78, 0x3db504f3
  s_mov_b32 s79, 0x3fb8aa3b
  v_mov_b32 v9, 120064
  v_mov_b32 v12, 1
  v_mov_b32 v13, 122912
  s_waitcnt lgkmcnt(0)
  s_barrier
  ds_read_b128 v[112:115], v152 offset:0
  ds_read_b128 v[116:119], v152 offset:64
  ds_read_b128 v[120:123], v152 offset:128
  ds_read_b128 v[124:127], v152 offset:192
  ds_read_b64 v[10:11], v9
  s_waitcnt lgkmcnt(4)
  v_mfma_f32_16x16x32_bf16 v[128:131], v[16:19], v[112:115], 0
  v_mfma_f32_16x16x32_bf16 v[132:135], v[32:35], v[112:115], 0
  s_waitcnt lgkmcnt(3)
  v_mfma_f32_16x16x32_bf16 v[128:131], v[20:23], v[116:119], v[128:131]
  v_mfma_f32_16x16x32_bf16 v[132:135], v[36:39], v[116:119], v[132:135]
  s_waitcnt lgkmcnt(2)
  v_mfma_f32_16x16x32_bf16 v[128:131], v[24:27], v[120:123], v[128:131]
  v_mfma_f32_16x16x32_bf16 v[132:135], v[40:43], v[120:123], v[132:135]
  s_waitcnt lgkmcnt(1)
  v_mfma_f32_16x16x32_bf16 v[128:131], v[28:31], v[124:127], v[128:131]
  v_mfma_f32_16x16x32_bf16 v[132:135], v[44:47], v[124:127], v[132:135]
  s_waitcnt lgkmcnt(0)
  v_mov_b32 v7, v10
  v_readfirstlane_b32 s54, v11
  s_nop 3
  v_cvt_pk_bf16_f32 v140, v128, v129
  v_cvt_pk_bf16_f32 v141, v130, v131
  v_cvt_pk_bf16_f32 v142, v132, v133
  v_cvt_pk_bf16_f32 v143, v134, v135
  v_and_b32 v129, 0xffff0000, v140
  v_lshlrev_b32 v128, 16, v140
  v_and_b32 v131, 0xffff0000, v141
  v_lshlrev_b32 v130, 16, v141
  v_and_b32 v133, 0xffff0000, v142
  v_lshlrev_b32 v132, 16, v142
  v_and_b32 v135, 0xffff0000, v143
  v_lshlrev_b32 v134, 16, v143
  v_mul_f32 v128, s78, v128
  v_mul_f32 v129, s78, v129
  v_mul_f32 v130, s78, v130
  v_mul_f32 v131, s78, v131
  v_mul_f32 v132, s78, v132
  v_mul_f32 v133, s78, v133
  v_mul_f32 v134, s78, v134
  v_mul_f32 v135, s78, v135
  v_cvt_pk_bf16_f32 v140, v128, v129
  v_cvt_pk_bf16_f32 v141, v130, v131
  v_cvt_pk_bf16_f32 v142, v132, v133
  v_cvt_pk_bf16_f32 v143, v134, v135
  v_and_b32 v129, 0xffff0000, v140
  v_lshlrev_b32 v128, 16, v140
  v_and_b32 v131, 0xffff0000, v141
  v_lshlrev_b32 v130, 16, v141
  v_and_b32 v133, 0xffff0000, v142
  v_lshlrev_b32 v132, 16, v142
  v_and_b32 v135, 0xffff0000, v143
  v_lshlrev_b32 v134, 16, v143
  v_max3_f32 v140, v128, v129, v130
  v_max3_f32 v141, v131, v132, v133
  v_max3_f32 v140, v140, v134, v135
  v_max_f32 v140, v140, v141
  v_mov_b32 v141, v140
  s_nop 1
  v_permlane32_swap_b32 v140, v141
  v_max_f32 v140, v140, v141
  v_mov_b32 v141, v140
  s_nop 1
  v_permlane16_swap_b32 v140, v141
  v_max_f32 v144, v140, v141
  v_mul_f32 v140, s79, v144
  v_fma_f32 v128, v128, s79, -v140
  v_fma_f32 v129, v129, s79, -v140
  v_fma_f32 v130, v130, s79, -v140
  v_fma_f32 v131, v131, s79, -v140
  v_fma_f32 v132, v132, s79, -v140
  v_fma_f32 v133, v133, s79, -v140
  v_fma_f32 v134, v134, s79, -v140
  v_fma_f32 v135, v135, s79, -v140
  v_exp_f32 v128, v128
  v_exp_f32 v129, v129
  v_exp_f32 v130, v130
  v_exp_f32 v131, v131
  v_exp_f32 v132, v132
  v_exp_f32 v133, v133
  v_exp_f32 v134, v134
  v_exp_f32 v135, v135
  v_cvt_pk_bf16_f32 v136, v128, v129
  v_cvt_pk_bf16_f32 v137, v130, v131
  v_cvt_pk_bf16_f32 v138, v132, v133
  v_cvt_pk_bf16_f32 v139, v134, v135
  v_cndmask_b32 v112, 0, v136, s[68:69]
  v_cndmask_b32 v113, 0, v137, s[68:69]
  v_cndmask_b32 v114, 0, v138, s[68:69]
  v_cndmask_b32 v115, 0, v139, s[68:69]
  v_cndmask_b32 v116, 0, v136, s[70:71]
  v_cndmask_b32 v117, 0, v137, s[70:71]
  v_cndmask_b32 v118, 0, v138, s[70:71]
  v_cndmask_b32 v119, 0, v139, s[70:71]
  v_cndmask_b32 v120, 0, v136, s[72:73]
  v_cndmask_b32 v121, 0, v137, s[72:73]
  v_cndmask_b32 v122, 0, v138, s[72:73]
  v_cndmask_b32 v123, 0, v139, s[72:73]
  v_cndmask_b32 v124, 0, v136, s[74:75]
  v_cndmask_b32 v125, 0, v137, s[74:75]
  v_cndmask_b32 v126, 0, v138, s[74:75]
  v_cndmask_b32 v127, 0, v139, s[74:75]
  v_add_f32 v140, v128, v129
  v_add_f32 v141, v130, v131
  v_add_f32 v142, v132, v133
  v_add_f32 v143, v134, v135
  v_add_f32 v140, v140, v141
  v_add_f32 v142, v142, v143
  v_add_f32 v140, v140, v142
  v_mov_b32 v141, v140
  s_nop 1
  v_permlane32_swap_b32 v140, v141
  v_add_f32 v140, v140, v141
  v_mov_b32 v141, v140
  s_nop 1
  v_permlane16_swap_b32 v140, v141
  v_add_f32 v140, v140, v141
  s_mov_b64 exec, 15
  ds_write_b32 v153, v144
  ds_write_b32 v153, v140 offset:128
  s_mov_b64 exec, 1
  ds_add_u32 v13, v12
  s_mov_b64 exec, -1
  s_cmp_lt_u32 s45, 14
  s_cbranch_scc1 L_exf_4
  s_cmp_ge_u32 s45, 30
  s_cbranch_scc1 L_exi_5
  s_add_u32 m0, s3, 4096
  s_add_u32 s50, s15, 0
  buffer_load_dwordx4 v4, s[40:43], s50 offen nt lds
  s_add_u32 m0, s3, 5120
  s_add_u32 s50, s15, 2048
  buffer_load_dwordx4 v5, s[40:43], s50 offen nt lds
  s_add_u32 m0, s3, 6144
  s_add_u32 s50, s15, 4096
  buffer_load_dwordx4 v4, s[40:43], s50 offen nt lds
  s_add_u32 m0, s3, 7168
  s_add_u32 s50, s15, 6144
  buffer_load_dwordx4 v5, s[40:43], s50 offen nt lds
  s_branch L_exe_6
L_exf_4:
  s_add_u32 s28, s16, s14
  s_addc_u32 s29, s17, 0
  s_and_b32 s29, s29, 0xffff
  s_mov_b32 s30, 1831456
  s_mov_b32 s31, 0x20000
  s_add_u32 s32, s18, s14
  s_addc_u32 s33, s19, 0
  s_and_b32 s33, s33, 0xffff
  s_mov_b32 s34, 1831456
  s_mov_b32 s35, 0x20000
  s_mov_b64 exec, 1
  buffer_load_dword v158, v5, s[28:31], 0 offen
  buffer_load_dword v159, v5, s[32:35], 0 offen
  buffer_load_dword v158, v5, s[40:43], 0 offen
  buffer_load_dword v159, v5, s[40:43], 0 offen
  s_mov_b64 exec, -1
  s_branch L_exe_6
L_exi_5:
  s_mov_b64 exec, 1
  buffer_load_dword v158, v5, s[40:43], 0 offen
  buffer_load_dword v158, v5, s[40:43], 0 offen
  buffer_load_dword v158, v5, s[40:43], 0 offen
  buffer_load_dword v158, v5, s[40:43], 0 offen
  s_mov_b64 exec, -1
L_exe_6:
  s_waitcnt vmcnt(4)
  ds_read_b64_tr_b16 v[82:83], v48
  ds_read_b64_tr_b16 v[98:99], v52
  ds_read_b64_tr_b16 v[86:87], v49
  ds_read_b64_tr_b16 v[102:103], v53
  ds_read_b64_tr_b16 v[90:91], v50
  ds_read_b64_tr_b16 v[106:107], v54
  ds_read_b64_tr_b16 v[94:95], v51
  ds_read_b64_tr_b16 v[110:111], v55
  s_waitcnt lgkmcnt(7)
  v_mfma_f32_16x16x32_bf16 v[128:131], v[80:83], v[112:115], 0
  s_waitcnt lgkmcnt(6)
  v_mfma_f32_16x16x32_bf16 v[132:135], v[96:99], v[112:115], 0
  s_waitcnt lgkmcnt(5)
  v_mfma_f32_16x16x32_bf16 v[128:131], v[84:87], v[116:119], v[128:131]
  s_waitcnt lgkmcnt(4)
  v_mfma_f32_16x16x32_bf16 v[132:135], v[100:103], v[116:119], v[132:135]
  s_waitcnt lgkmcnt(3)
  v_mfma_f32_16x16x32_bf16 v[128:131], v[88:91], v[120:123], v[128:131]
  s_waitcnt lgkmcnt(2)
  v_mfma_f32_16x16x32_bf16 v[132:135], v[104:107], v[120:123], v[132:135]
  s_waitcnt lgkmcnt(1)
  v_mfma_f32_16x16x32_bf16 v[128:131], v[92:95], v[124:127], v[128:131]
  s_waitcnt lgkmcnt(0)
  v_mfma_f32_16x16x32_bf16 v[132:135], v[108:111], v[124:127], v[132:135]
  s_nop 5
  ds_write_b128 v154, v[128:131] offset:0
  s_nop 0
  ds_write_b128 v154, v[132:135] offset:256
  s_waitcnt lgkmcnt(0)
  s_barrier
  s_cmp_ge_u32 s47, 2
  s_cbranch_scc1 L_nopub_7
  ds_read_b128 v[140:143], v156
  ds_read_b128 v[144:147], v156 offset:16
  ds_read_b128 v[48:51], v155 offset:0
  ds_read_b128 v[52:55], v155 offset:2112
  ds_read_b128 v[56:59], v155 offset:4224
  ds_read_b128 v[60:63], v155 offset:6336
  ds_read_b128 v[64:67], v155 offset:8448
  ds_read_b128 v[68:71], v155 offset:10560
  ds_read_b128 v[72:75], v155 offset:12672
  ds_read_b128 v[76:79], v155 offset:14784
  s_waitcnt lgkmcnt(7)
  v_pk_mul_f32 v[16:17], v[48:49], v[140:141] op_sel:[0,0] op_sel_hi:[1,0]
  v_pk_mul_f32 v[18:19], v[50:51], v[140:141] op_sel:[0,0] op_sel_hi:[1,0]
  s_waitcnt lgkmcnt(6)
  v_pk_mul_f32 v[20:21], v[52:53], v[140:141] op_sel:[0,1] op_sel_hi:[1,1]
  v_pk_mul_f32 v[22:23], v[54:55], v[140:141] op_sel:[0,1] op_sel_hi:[1,1]
  s_waitcnt lgkmcnt(5)
  v_pk_fma_f32 v[16:17], v[56:57], v[142:143], v[16:17] op_sel:[0,0,0] op_sel_hi:[1,0,1]
  v_pk_fma_f32 v[18:19], v[58:59], v[142:143], v[18:19] op_sel:[0,0,0] op_sel_hi:[1,0,1]
  s_waitcnt lgkmcnt(4)
  v_pk_fma_f32 v[20:21], v[60:61], v[142:143], v[20:21] op_sel:[0,1,0] op_sel_hi:[1,1,1]
  v_pk_fma_f32 v[22:23], v[62:63], v[142:143], v[22:23] op_sel:[0,1,0] op_sel_hi:[1,1,1]
  s_waitcnt lgkmcnt(3)
  v_pk_fma_f32 v[16:17], v[64:65], v[144:145], v[16:17] op_sel:[0,0,0] op_sel_hi:[1,0,1]
  v_pk_fma_f32 v[18:19], v[66:67], v[144:145], v[18:19] op_sel:[0,0,0] op_sel_hi:[1,0,1]
  s_waitcnt lgkmcnt(2)
  v_pk_fma_f32 v[20:21], v[68:69], v[144:145], v[20:21] op_sel:[0,1,0] op_sel_hi:[1,1,1]
  v_pk_fma_f32 v[22:23], v[70:71], v[144:145], v[22:23] op_sel:[0,1,0] op_sel_hi:[1,1,1]
  s_waitcnt lgkmcnt(1)
  v_pk_fma_f32 v[16:17], v[72:73], v[146:147], v[16:17] op_sel:[0,0,0] op_sel_hi:[1,0,1]
  v_pk_fma_f32 v[18:19], v[74:75], v[146:147], v[18:19] op_sel:[0,0,0] op_sel_hi:[1,0,1]
  s_waitcnt lgkmcnt(0)
  v_pk_fma_f32 v[20:21], v[76:77], v[146:147], v[20:21] op_sel:[0,1,0] op_sel_hi:[1,1,1]
  v_pk_fma_f32 v[22:23], v[78:79], v[146:147], v[22:23] op_sel:[0,1,0] op_sel_hi:[1,1,1]
  v_pk_add_f32 v[16:17], v[16:17], v[20:21]
  v_pk_add_f32 v[18:19], v[18:19], v[22:23]
  v_perm_b32 v16, v16, v7, s64
  v_perm_b32 v17, v17, v7, s65
  v_perm_b32 v18, v18, v7, s66
  v_perm_b32 v19, v19, v7, s67
  s_cmp_eq_u32 s54, 0
  s_cbranch_scc1 L_st_8
  buffer_store_dwordx4 v[16:19], v157, s[36:39], s6 offen offset:0
L_ste_9:
L_nopub_7:
  s_cmp_lt_u32 s45, 14
  s_cbranch_scc1 L_ffn1
  s_cmp_ge_u32 s45, 30
  s_cbranch_scc1 L_sdone
  v_lshrrev_b32 v8, 4, v0
  v_and_b32 v9, 3, v0
  v_bfe_u32 v11, v0, 2, 2
  v_and_b32 v10, 1, v8
  v_lshrrev_b32 v12, 1, v8
  v_lshl_add_u32 v13, v10, 1, v12
  v_lshl_add_u32 v10, v9, 2, v13
  s_lshl_b32 s49, s47, 6
  s_add_u32 s49, s49, 123136
  v_lshl_add_u32 v24, v10, 2, s49
  v_and_b32 v10, 1, v0
  v_lshlrev_b32 v12, 8, v10
  v_lshl_add_u32 v12, v8, 5, v12
  v_add_u32 v25, 123136, v12
  v_lshlrev_b32 v12, 6, v10
  v_lshl_add_u32 v12, v8, 4, v12
  v_bfe_u32 v14, v0, 1, 1
  v_lshl_add_u32 v28, v14, 13, v12
  s_lshl_b32 s49, s60, 4
  s_lshl_b32 s50, s47, 1
  s_add_u32 s49, s49, s50
  s_lshl_b32 s49, s49, 13
  s_lshl_b32 s50, s44, 3
  s_lshr_b32 s51, s63, 1
  s_add_u32 s50, s50, s51
  s_lshl_b32 s50, s50, 7
  s_add_u32 s49, s49, s50
  s_add_u32 s8, s49, 1048576
  v_and_b32 v12, 1, v8
  v_lshl_add_u32 v12, v12, 2, v11
  v_mul_u32_u24 v14, 12288, v8
  v_lshl_add_u32 v14, v11, 9, v14
  v_lshl_add_u32 v14, v9, 3, v14
  v_add_u32 v14, 22528, v14
  s_lshl_b32 s49, s47, 1
  v_xor_b32 v15, s49, v12
  v_lshl_add_u32 v26, v15, 5, v14
  v_xor_b32 v15, 1, v15
  v_lshl_add_u32 v27, v15, 5, v14
  s_mov_b32 s68, 0xc000c
  s_mov_b32 s69, 0xc000c
  s_lshl_b32 s49, s47, 10
  s_lshl_b32 s50, s63, 14
  s_add_u32 s50, s50, s49
  s_add_u32 s9, s50, 1048576
  s_add_u32 s15, s9, 8192
  s_lshl_b32 s50, s44, 12
  s_lshl_b32 s51, s63, 8
  s_add_u32 s50, s50, s51
  s_add_u32 s10, s50, 1310720
  s_lshl_b32 s50, s63, 1
  s_and_b32 s51, s50, 7
  s_xor_b32 s51, s51, s44
  s_add_u32 s50, s50, s51
  s_cmp_gt_u32 s51, 1
  s_cselect_b32 s14, -1, s50
  s_mul_i32 s50, s50, 14336
  s_add_u32 s50, s50, s49
  s_add_u32 s11, s50, 1572864
  v_and_b32 v10, 7, v0
  v_lshl_add_u32 v10, v10, 2, v13
  s_lshl_b32 s49, s47, 7
  s_add_u32 s49, s49, 120832
  v_lshl_add_u32 v29, v10, 2, s49
  v_and_b32 v10, 15, v0
  v_bfe_u32 v12, v0, 4, 1
  v_lshlrev_b32 v14, 2, v10
  v_add_u32 v31, 120832, v14
  v_lshl_add_u32 v30, v12, 10, v31
  v_and_b32 v12, 31, v0
  v_lshlrev_b32 v32, 3, v12
  v_lshlrev_b32 v33, 1, v10
  s_lshl_b32 s49, s63, 6
  v_lshl_add_u32 v34, v12, 1, s49
  buffer_load_dwordx4 v[40:43], v158, s[36:39], s7 offen offset:0 sc1
  ds_read_b32 v144, v159
  s_waitcnt vmcnt(0)
  s_waitcnt lgkmcnt(0)
  v_perm_b32 v140, v41, v40, s61
  v_perm_b32 v141, v43, v42, s62
  v_bitop3_b32 v140, v140, v141, v7 bitop3:0x56
  v_cmp_ne_u32 vcc, 0, v140
  s_cbranch_vccnz L_retry_10
L_done_12:
  v_cmp_gt_f32 vcc, 0, v144
  s_cbranch_vccnz L_wretry_14
L_wok_13:
  v_mul_f32 v60, v144, v40
  v_mul_f32 v61, v144, v41
  v_mul_f32 v62, v144, v42
  v_mul_f32 v63, v144, v43
  v_permlane32_swap_b32 v60, v61
  s_nop 0
  v_permlane32_swap_b32 v62, v63
  v_add_f32 v60, v60, v61
  v_add_f32 v62, v62, v63
  s_nop 1
  v_permlane16_swap_b32 v60, v62
  v_add_f32 v60, v60, v62
  s_nop 1
  v_add_f32_dpp v60, v60, v60 row_ror:8 row_mask:0xf bank_mask:0xf
  s_nop 1
  v_add_f32_dpp v60, v60, v60 row_ror:4 row_mask:0xf bank_mask:0xf
  s_mov_b32 exec_lo, 0xf000f
  s_mov_b32 exec_hi, 0xf000f
  ds_write_b32 v24, v60
  s_mov_b64 exec, -1
  s_waitcnt lgkmcnt(0)
  s_barrier
  ds_read_b128 v[60:63], v25 offset:0
  ds_read_b128 v[64:67], v25 offset:16
  ds_read_b128 v[68:71], v25 offset:128
  ds_read_b128 v[72:75], v25 offset:144
  ds_read_b64_tr_b16 v[92:93], v26 offset:0
  ds_read_b64_tr_b16 v[94:95], v26 offset:2048
  ds_read_b64_tr_b16 v[96:97], v26 offset:49152
  ds_read_b64_tr_b16 v[98:99], v26 offset:51200
  ds_read_b64_tr_b16 v[100:101], v27 offset:0
  ds_read_b64_tr_b16 v[102:103], v27 offset:2048
  ds_read_b64_tr_b16 v[104:105], v27 offset:49152
  ds_read_b64_tr_b16 v[106:107], v27 offset:51200
  s_waitcnt lgkmcnt(10)
  v_cvt_pk_bf16_f32 v136, v60, v61
  v_cvt_pk_bf16_f32 v137, v62, v63
  v_cvt_pk_bf16_f32 v138, v64, v65
  v_cvt_pk_bf16_f32 v139, v66, v67
  s_waitcnt lgkmcnt(8)
  v_cvt_pk_bf16_f32 v140, v68, v69
  v_cvt_pk_bf16_f32 v141, v70, v71
  v_cvt_pk_bf16_f32 v142, v72, v73
  v_cvt_pk_bf16_f32 v143, v74, v75
  s_waitcnt lgkmcnt(6)
  v_mfma_f32_16x16x32_bf16 v[128:131], v[92:95], v[136:139], 0
  s_waitcnt lgkmcnt(4)
  v_mfma_f32_16x16x32_bf16 v[128:131], v[96:99], v[140:143], v[128:131]
  s_waitcnt lgkmcnt(2)
  v_mfma_f32_16x16x32_bf16 v[132:135], v[100:103], v[136:139], 0
  s_waitcnt lgkmcnt(0)
  v_mfma_f32_16x16x32_bf16 v[132:135], v[104:107], v[140:143], v[132:135]
  s_mov_b32 exec_lo, 0xf000f
  s_mov_b32 exec_hi, 0xf000f
  s_nop 5
  v_cndmask_b32 v128, v128, v132, s[68:69]
  v_cndmask_b32 v129, v129, v133, s[68:69]
  v_cndmask_b32 v130, v130, v134, s[68:69]
  v_cndmask_b32 v131, v131, v135, s[68:69]
  v_perm_b32 v128, v128, v7, s64
  v_perm_b32 v129, v129, v7, s65
  v_perm_b32 v130, v130, v7, s66
  v_perm_b32 v131, v131, v7, s67
  buffer_store_dwordx4 v[128:131], v28, s[36:39], s8 offen offset:0 sc1
  s_mov_b64 exec, -1
  s_waitcnt vmcnt(0)
  s_cmp_lg_u32 s47, 0
  s_cbranch_scc1 L_nox_15
  s_mov_b32 s40, s4
  s_and_b32 s41, s5, 0xffff
  s_mov_b32 s42, 2048
  s_mov_b32 s43, 0x20000
  buffer_load_ushort v5, v34, s[40:43], 0 offen
  buffer_load_ushort v6, v34, s[40:43], 0 offen offset:1024
L_nox_15:
  buffer_load_dwordx4 v[44:47], v157, s[36:39], s9 offen offset:0 sc1
  buffer_load_dwordx4 v[48:51], v157, s[36:39], s15 offen offset:0 sc1
  s_mov_b32 s55, 20000
L_pp_16:
  buffer_load_dwordx4 v[44:47], v157, s[36:39], s9 offen offset:0 sc1
  buffer_load_dwordx4 v[48:51], v157, s[36:39], s15 offen offset:0 sc1
  s_waitcnt vmcnt(2)
  v_perm_b32 v140, v45, v44, s61
  v_perm_b32 v141, v47, v46, s62
  v_bitop3_b32 v140, v140, v141, v7 bitop3:0x56
  v_perm_b32 v142, v49, v48, s61
  v_perm_b32 v143, v51, v50, s62
  v_bitop3_b32 v142, v142, v143, v7 bitop3:0x56
  v_or_b32 v140, v140, v142
  v_cmp_ne_u32 vcc, 0, v140
  s_cbranch_vccz L_ppd_17
  s_mov_b64 exec, vcc
  s_sub_u32 s55, s55, 1
  s_cbranch_scc0 L_pp_16
L_ppd_17:
  s_mov_b64 exec, -1
  v_mov_b32 v60, v44
  v_mov_b32 v61, v45
  v_mov_b32 v62, v46
  v_mov_b32 v63, v47
  v_mov_b32 v64, v48
  v_mov_b32 v65, v49
  v_mov_b32 v66, v50
  v_mov_b32 v67, v51
  v_permlane32_swap_b32 v60, v61
  v_permlane32_swap_b32 v62, v63
  v_permlane32_swap_b32 v64, v65
  v_permlane32_swap_b32 v66, v67
  v_add_f32 v60, v60, v61
  v_add_f32 v62, v62, v63
  v_add_f32 v64, v64, v65
  v_add_f32 v66, v66, v67
  v_permlane16_swap_b32 v60, v62
  s_nop 0
  v_permlane16_swap_b32 v64, v66
  v_add_f32 v60, v60, v62
  v_add_f32 v64, v64, v66
  s_nop 0
  v_add_f32_dpp v60, v60, v60 row_ror:8 row_mask:0xf bank_mask:0xf
  v_add_f32_dpp v64, v64, v64 row_ror:8 row_mask:0xf bank_mask:0xf
  s_mov_b32 exec_lo, 0xff00ff
  s_mov_b32 exec_hi, 0xff00ff
  ds_write_b32 v29, v60 offset:0
  ds_write_b32 v29, v64 offset:1024
  s_mov_b64 exec, -1
  s_waitcnt lgkmcnt(0)
  s_barrier
  s_cmp_lg_u32 s47, 0
  s_cbranch_scc1 L_noh_18
  ds_read2_b32 v[60:61], v30 offset0:0 offset1:16
  ds_read2_b32 v[62:63], v30 offset0:32 offset1:48
  ds_read2_b32 v[64:65], v30 offset0:64 offset1:80
  ds_read2_b32 v[66:67], v30 offset0:96 offset1:112
  ds_read2_b32 v[68:69], v30 offset0:128 offset1:144
  ds_read2_b32 v[70:71], v30 offset0:160 offset1:176
  ds_read2_b32 v[72:73], v30 offset0:192 offset1:208
  ds_read2_b32 v[74:75], v30 offset0:224 offset1:240
  v_lshlrev_b32 v5, 16, v5
  v_lshlrev_b32 v6, 16, v6
  s_waitcnt lgkmcnt(6)
  v_pk_add_f32 v[60:61], v[60:61], v[62:63]
  s_waitcnt lgkmcnt(4)
  v_pk_add_f32 v[64:65], v[64:65], v[66:67]
  s_waitcnt lgkmcnt(2)
  v_pk_add_f32 v[68:69], v[68:69], v[70:71]
  s_waitcnt lgkmcnt(0)
  v_pk_add_f32 v[72:73], v[72:73], v[74:75]
  v_pk_add_f32 v[60:61], v[60:61], v[64:65]
  v_pk_add_f32 v[68:69], v[68:69], v[72:73]
  v_pk_add_f32 v[60:61], v[60:61], v[68:69]
  v_cvt_pk_bf16_f32 v142, v60, v61
  v_and_b32 v141, 0xffff0000, v142
  v_lshlrev_b32 v140, 16, v142
  v_add_f32 v140, v5, v140
  v_add_f32 v141, v6, v141
  v_cvt_pk_bf16_f32 v140, v140, v141
  v_mov_b32 v141, v7
  s_mov_b32 exec_hi, 0
  s_cmp_eq_u32 s54, 0
  s_cbranch_scc1 L_st_19
  buffer_store_dwordx2 v[140:141], v32, s[36:39], s10 offen offset:0
L_ste_20:
  s_mov_b64 exec, -1
  v_and_b32 v6, 0xffff0000, v140
  v_lshlrev_b32 v5, 16, v140
L_noh_18:
  s_cmp_eq_u32 s14, -1
  s_cbranch_scc1 L_sdone
  s_mov_b32 s40, s22
  s_and_b32 s41, s23, 0xffff
  s_mov_b32 s42, 2048
  s_mov_b32 s43, 0x20000
  s_lshl_b32 s49, s44, 7
  s_add_u32 s49, s49, 405504
  v_min_u32 v9, 13, v0
  v_lshlrev_b32 v9, 2, v9
  buffer_load_dword v10, v9, s[36:39], s49 offen offset:0 sc1
  s_waitcnt vmcnt(0)
  v_cmp_ne_u32 vcc, v10, v7
  s_cbranch_vccnz L_retry_21
L_done_23:
  s_add_u32 s15, s11, 8192
  s_cmp_ge_u32 s47, 6
  s_cbranch_scc1 L_w6_24
  buffer_load_dwordx4 v[52:55], v157, s[36:39], s11 offen offset:0 sc1
  buffer_load_dwordx4 v[56:59], v157, s[36:39], s15 offen offset:0 sc1
  s_mov_b32 s55, 20000
L_pp_26:
  buffer_load_dwordx4 v[52:55], v157, s[36:39], s11 offen offset:0 sc1
  buffer_load_dwordx4 v[56:59], v157, s[36:39], s15 offen offset:0 sc1
  s_waitcnt vmcnt(2)
  v_perm_b32 v140, v53, v52, s61
  v_perm_b32 v141, v55, v54, s62
  v_bitop3_b32 v140, v140, v141, v7 bitop3:0x56
  v_perm_b32 v142, v57, v56, s61
  v_perm_b32 v143, v59, v58, s62
  v_bitop3_b32 v142, v142, v143, v7 bitop3:0x56
  v_or_b32 v140, v140, v142
  v_cmp_ne_u32 vcc, 0, v140
  s_cbranch_vccz L_ppd_27
  s_mov_b64 exec, vcc
  s_sub_u32 s55, s55, 1
  s_cbranch_scc0 L_pp_26
L_ppd_27:
  s_mov_b64 exec, -1
  v_pk_add_f32 v[60:61], v[52:53], v[56:57]
  v_pk_add_f32 v[62:63], v[54:55], v[58:59]
  s_nop 0
  v_permlane32_swap_b32 v60, v61
  v_permlane32_swap_b32 v62, v63
  v_add_f32 v60, v60, v61
  v_add_f32 v62, v62, v63
  s_nop 1
  v_permlane16_swap_b32 v60, v62
  v_add_f32 v60, v60, v62
  s_nop 1
  v_add_f32_dpp v60, v60, v60 row_ror:8 row_mask:0xf bank_mask:0xf
  s_mov_b32 exec_lo, 0xff00ff
  s_mov_b32 exec_hi, 0xff00ff
  ds_write_b32 v29, v60 offset:0
  s_mov_b64 exec, -1
  s_waitcnt lgkmcnt(0)
  s_branch L_w6e_25
L_w6_24:
  buffer_load_dwordx4 v[52:55], v157, s[36:39], s11 offen offset:0 sc1
  s_mov_b32 s55, 20000
L_pp_28:
  buffer_load_dwordx4 v[52:55], v157, s[36:39], s11 offen offset:0 sc1
  s_waitcnt vmcnt(1)
  v_perm_b32 v140, v53, v52, s61
  v_perm_b32 v141, v55, v54, s62
  v_bitop3_b32 v140, v140, v141, v7 bitop3:0x56
  v_cmp_ne_u32 vcc, 0, v140
  s_cbranch_vccz L_ppd_29
  s_mov_b64 exec, vcc
  s_sub_u32 s55, s55, 1
  s_cbranch_scc0 L_pp_28
L_ppd_29:
  s_mov_b64 exec, -1
  v_mov_b32 v60, v52
  v_mov_b32 v61, v53
  v_mov_b32 v62, v54
  v_mov_b32 v63, v55
  v_permlane32_swap_b32 v60, v61
  s_nop 0
  v_permlane32_swap_b32 v62, v63
  v_add_f32 v60, v60, v61
  v_add_f32 v62, v62, v63
  s_nop 1
  v_permlane16_swap_b32 v60, v62
  v_add_f32 v60, v60, v62
  s_nop 1
  v_add_f32_dpp v60, v60, v60 row_ror:8 row_mask:0xf bank_mask:0xf
  s_mov_b32 exec_lo, 0xff00ff
  s_mov_b32 exec_hi, 0xff00ff
  ds_write_b32 v29, v60 offset:0
  s_mov_b64 exec, -1
  s_waitcnt lgkmcnt(0)
L_w6e_25:
  s_barrier
  s_cmp_lg_u32 s47, 0
  s_cbranch_scc1 L_sdone
  ds_read2_b32 v[60:61], v31 offset0:0 offset1:16
  ds_read2_b32 v[62:63], v31 offset0:32 offset1:48
  ds_read2_b32 v[64:65], v31 offset0:64 offset1:80
  ds_read2_b32 v[66:67], v31 offset0:96 offset1:112
  ds_read2_b32 v[68:69], v31 offset0:128 offset1:144
  ds_read2_b32 v[70:71], v31 offset0:160 offset1:176
  ds_read2_b32 v[72:73], v31 offset0:192 offset1:208
  ds_read2_b32 v[74:75], v31 offset0:224 offset1:240
  s_and_b32 s49, s14, 1
  s_lshl_b32 s49, s49, 4
  s_lshl_b32 s52, s14, 5
  s_waitcnt lgkmcnt(6)
  v_pk_add_f32 v[60:61], v[60:61], v[62:63]
  s_waitcnt lgkmcnt(4)
  v_pk_add_f32 v[64:65], v[64:65], v[66:67]
  s_waitcnt lgkmcnt(2)
  v_pk_add_f32 v[68:69], v[68:69], v[70:71]
  s_waitcnt lgkmcnt(0)
  v_pk_add_f32 v[72:73], v[72:73], v[74:75]
  v_pk_add_f32 v[60:61], v[60:61], v[64:65]
  v_pk_add_f32 v[68:69], v[68:69], v[72:73]
  v_pk_add_f32 v[60:61], v[60:61], v[68:69]
  v_cvt_pk_bf16_f32 v142, v60, v61
  v_and_b32 v141, 0xffff0000, v142
  v_lshlrev_b32 v140, 16, v142
  v_add_f32 v140, v140, v5
  v_add_f32 v141, v141, v6
  v_cvt_pk_bf16_f32 v140, v140, v141
  s_lshl_b64 exec, 0xffff, s49
  buffer_store_short v140, v33, s[40:43], s52 offen
  buffer_store_short_d16_hi v140, v33, s[40:43], s52 offen offset:1024
  s_mov_b64 exec, -1
  s_branch L_sdone
L_ffn1:
  s_lshl_b32 s51, s47, 11
  s_lshl_b32 s52, s47, 7
  s_add_u32 m0, s51, 51200
  s_add_u32 s49, s52, 0
  buffer_load_dwordx4 v4, s[40:43], s49 offen nt lds
  s_add_u32 m0, s51, 52224
  s_add_u32 s49, s52, 8192
  buffer_load_dwordx4 v4, s[40:43], s49 offen nt lds
  v_lshrrev_b32 v10, 1, v0
  v_mul_u32_u24 v10, 3584, v10
  v_and_b32 v12, 1, v0
  v_lshl_add_u32 v24, v12, 4, v10
  s_lshl_b32 s51, s47, 11
  s_mul_i32 s52, s47, 229376
  v_mov_b32 v10, 122924
  ds_read_b32 v11, v10
  s_waitcnt lgkmcnt(0)
  v_cmp_eq_u32 vcc, 0, v11
  s_cbranch_vccnz L_retry_30
L_done_32:
  s_add_u32 m0, s51, 18432
  s_add_u32 s49, s52, 0
  buffer_load_dwordx4 v24, s[28:31], s49 offen nt lds
  s_add_u32 m0, s51, 19456
  s_add_u32 s49, s52, 114688
  buffer_load_dwordx4 v24, s[28:31], s49 offen nt lds
  s_add_u32 m0, s51, 34816
  s_add_u32 s49, s52, 0
  buffer_load_dwordx4 v24, s[32:35], s49 offen nt lds
  s_add_u32 m0, s51, 35840
  s_add_u32 s49, s52, 114688
  buffer_load_dwordx4 v24, s[32:35], s49 offen nt lds
  v_lshrrev_b32 v8, 4, v0
  v_and_b32 v9, 3, v0
  v_bfe_u32 v11, v0, 2, 2
  v_lshl_add_u32 v10, v8, 3, v11
  v_lshlrev_b32 v10, 5, v10
  v_lshl_add_u32 v10, v9, 3, v10
  s_add_u32 s50, s51, 18432
  v_add_u32 v25, s50, v10
  v_lshl_add_u32 v10, v8, 2, v11
  v_bfe_u32 v14, v10, 1, 2
  v_lshlrev_b32 v10, 7, v10
  v_lshl_add_u32 v10, v9, 3, v10
  s_add_u32 s50, s51, 51200
  v_add_u32 v10, s50, v10
  v_xor_b32 v15, 0, v14
  v_lshl_add_u32 v26, v15, 5, v10
  v_xor_b32 v15, 1, v14
  v_lshl_add_u32 v27, v15, 5, v10
  v_xor_b32 v15, 2, v14
  v_lshl_add_u32 v28, v15, 5, v10
  v_xor_b32 v15, 3, v14
  v_lshl_add_u32 v29, v15, 5, v10
  v_and_b32 v10, 31, v0
  v_lshlrev_b32 v30, 4, v10
  s_lshl_b32 s49, s47, 9
  s_lshl_b32 s50, s44, 12
  s_add_u32 s49, s49, s50
  s_add_u32 s9, s49, 1310720
  v_mov_b32 v31, s76
  v_mov_b32 v14, s77
  v_cmp_gt_u32 vcc, 32, v0
  s_nop 1
  v_cndmask_b32 v31, v14, v31, vcc
  s_lshl_b32 s49, s47, 4
  s_add_u32 s49, s49, 123648
  v_lshl_add_u32 v32, v8, 2, s49
  v_lshrrev_b32 v14, 5, v0
  v_and_b32 v15, 7, v0
  v_lshlrev_b32 v15, 4, v15
  v_lshl_add_u32 v15, v14, 3, v15
  v_add_u32 v33, 123648, v15
  s_lshl_b32 s49, s47, 10
  s_add_u32 s50, s49, 124928
  v_lshlrev_b32 v10, 2, v10
  v_lshl_add_u32 v10, v14, 7, v10
  v_add_u32 v34, s50, v10
  v_lshlrev_b32 v10, 7, v12
  v_lshl_add_u32 v10, v8, 4, v10
  v_add_u32 v35, s50, v10
  v_and_b32 v10, 15, v0
  v_mov_b32 v14, 120320
  v_cmp_gt_u32 vcc, 2, v10
  s_nop 1
  v_cndmask_b32 v35, v14, v35, vcc
  v_lshlrev_b32 v14, 2, v0
  v_add_u32 v14, 120320, v14
  v_mov_b32 v15, 0x3f803f80
  s_mov_b32 exec_hi, 0
  ds_write_b32 v14, v15
  s_mov_b64 exec, -1
  v_lshlrev_b32 v14, 5, v10
  v_add_u32 v14, 125184, v14
  v_add_u32 v36, s49, v14
  v_lshl_add_u32 v37, v8, 11, v14
  v_lshrrev_b32 v14, 5, v0
  v_lshlrev_b32 v14, 5, v14
  v_lshl_add_u32 v14, v10, 1, v14
  s_add_u32 s50, s50, 768
  v_add_u32 v38, s50, v14
  v_lshlrev_b32 v14, 5, v12
  v_lshl_add_u32 v14, v8, 3, v14
  v_add_u32 v39, s50, v14
  v_bfe_u32 v14, v0, 1, 2
  s_lshl_b32 s49, s47, 2
  v_add_u32 v14, s49, v14
  v_mul_u32_u24 v14, 14336, v14
  v_lshlrev_b32 v15, 6, v12
  v_lshl_add_u32 v15, v8, 4, v15
  v_add_u32 v5, v14, v15
  s_mul_i32 s49, s44, 14
  s_add_u32 s49, s49, s45
  s_lshl_b32 s49, s49, 7
  s_add_u32 s10, s49, 1572864
  s_mov_b32 s68, 0xc000c
  s_mov_b32 s69, 0xc000c
  s_mov_b32 s70, 0x300030
  s_mov_b32 s71, 0x300030
  s_mov_b32 s72, 0xc000c0
  s_mov_b32 s73, 0xc000c0
  s_mov_b32 s78, 0xbfb8aa3b
  s_waitcnt vmcnt(0)
  ds_read_b64_tr_b16 v[84:85], v25 offset:0
  ds_read_b64_tr_b16 v[86:87], v25 offset:128
  ds_read_b64_tr_b16 v[88:89], v25 offset:1024
  ds_read_b64_tr_b16 v[90:91], v25 offset:1152
  ds_read_b64_tr_b16 v[92:93], v25 offset:16384
  ds_read_b64_tr_b16 v[94:95], v25 offset:16512
  ds_read_b64_tr_b16 v[96:97], v25 offset:17408
  ds_read_b64_tr_b16 v[98:99], v25 offset:17536
  ds_read_b64_tr_b16 v[100:101], v26
  ds_read_b64_tr_b16 v[102:103], v27
  ds_read_b64_tr_b16 v[104:105], v28
  ds_read_b64_tr_b16 v[106:107], v29
  buffer_load_dwordx4 v[40:43], v30, s[36:39], s9 offen offset:0 sc1
  s_waitcnt vmcnt(0)
  v_xor_b32 v140, v41, v7
  v_bitop3_b32 v140, v140, v43, v7 bitop3:0xf6
  v_cmp_ne_u32 vcc, 0, v140
  s_cbranch_vccnz L_retry_33
L_done_35:
  v_perm_b32 v140, v42, v40, v31
  ds_write_b32 v34, v140
  v_and_b32 v143, 0xffff0000, v140
  v_lshlrev_b32 v142, 16, v140
  v_add_f32 v144, v142, v143
  v_mul_f32 v145, v142, v142
  v_fmac_f32 v145, v143, v143
  s_waitcnt lgkmcnt(0)
  ds_read_b128 v[60:63], v35
  ds_read_b128 v[64:67], v35 offset:64
  v_permlane16_swap_b32 v144, v145
  v_add_f32 v144, v144, v145
  s_nop 1
  v_add_f32_dpp v144, v144, v144 row_ror:8 row_mask:0xf bank_mask:0xf
  s_nop 1
  v_add_f32_dpp v144, v144, v144 row_ror:4 row_mask:0xf bank_mask:0xf
  s_waitcnt lgkmcnt(1)
  v_mfma_f32_16x16x32_bf16 v[128:131], v[60:63], v[84:87], 0
  v_mfma_f32_16x16x32_bf16 v[132:135], v[60:63], v[92:95], 0
  s_waitcnt lgkmcnt(0)
  v_mfma_f32_16x16x32_bf16 v[128:131], v[64:67], v[88:91], v[128:131]
  v_mfma_f32_16x16x32_bf16 v[132:135], v[64:67], v[96:99], v[132:135]
  v_add_f32_dpp v144, v144, v144 row_ror:2 row_mask:0xf bank_mask:0xf
  s_nop 1
  v_add_f32_dpp v144, v144, v144 row_ror:1 row_mask:0xf bank_mask:0xf
  s_mov_b32 exec_lo, 0x10001
  s_mov_b32 exec_hi, 0x10001
  ds_write_b32 v32, v144
  s_mov_b32 exec_lo, 0xffff
  s_mov_b32 exec_hi, 0x0
  ds_write_b128 v36, v[128:131]
  ds_write_b128 v36, v[132:135] offset:16
  s_mov_b64 exec, -1
  s_waitcnt lgkmcnt(0)
  s_barrier
  ds_read_b64 v[144:145], v33
  ds_read_b128 v[44:47], v37 offset:0
  ds_read_b128 v[48:51], v37 offset:16
  ds_read_b128 v[52:55], v37 offset:1024
  ds_read_b128 v[56:59], v37 offset:1040
  s_waitcnt lgkmcnt(4)
  v_add_f32_dpp v144, v144, v144 row_ror:4 row_mask:0xf bank_mask:0xf
  v_add_f32_dpp v145, v145, v145 row_ror:4 row_mask:0xf bank_mask:0xf
  s_nop 0
  v_add_f32_dpp v144, v144, v144 row_ror:2 row_mask:0xf bank_mask:0xf
  v_add_f32_dpp v145, v145, v145 row_ror:2 row_mask:0xf bank_mask:0xf
  s_nop 0
  v_add_f32_dpp v144, v144, v144 row_ror:1 row_mask:0xf bank_mask:0xf
  v_add_f32_dpp v145, v145, v145 row_ror:1 row_mask:0xf bank_mask:0xf
  s_waitcnt lgkmcnt(0)
  v_mul_f32 v144, 0x3b000000, v144
  v_pk_add_f32 v[44:45], v[44:45], v[52:53]
  v_mul_f32 v145, 0x3b000000, v145
  v_pk_add_f32 v[46:47], v[46:47], v[54:55]
  v_fma_f32 v145, -v144, v144, v145
  v_pk_add_f32 v[48:49], v[48:49], v[56:57]
  v_max_f32 v145, 0, v145
  v_pk_add_f32 v[50:51], v[50:51], v[58:59]
  v_cvt_pk_bf16_f32 v146, v144, v145
  v_permlane32_swap_b32 v44, v45
  v_lshlrev_b32 v144, 16, v146
  v_permlane32_swap_b32 v48, v49
  v_and_b32 v145, 0xffff0000, v146
  v_permlane32_swap_b32 v46, v47
  v_add_f32 v145, 0x3727c5ac, v145
  v_permlane32_swap_b32 v50, v51
  v_cvt_pk_bf16_f32 v145, v145, v145
  v_add_f32 v44, v44, v45
  v_and_b32 v145, 0xffff0000, v145
  v_add_f32 v48, v48, v49
  v_sqrt_f32 v145, v145
  v_add_f32 v46, v46, v47
  v_cvt_pk_bf16_f32 v145, v145, v145
  v_add_f32 v50, v50, v51
  v_and_b32 v145, 0xffff0000, v145
  v_permlane16_swap_b32 v44, v48
  v_rcp_f32 v146, v145
  v_permlane16_swap_b32 v46, v50
  v_add_f32 v44, v44, v48
  v_add_f32 v46, v46, v50
  v_fma_f32 v44, -v144, v46, v44
  v_mul_f32 v44, v44, v146
  v_cvt_pk_bf16_f32 v44, v44, v44
  v_and_b32 v44, 0xffff0000, v44
  v_mov_b32 v45, v44
  s_nop 1
  v_permlane16_swap_b32 v44, v45
  v_mul_f32 v46, s78, v44
  v_exp_f32 v46, v46
  s_nop 0
  v_add_f32 v46, 1.0, v46
  v_rcp_f32 v46, v46
  s_nop 0
  v_mul_f32 v44, v44, v46
  v_cvt_pk_bf16_f32 v44, v44, v44
  v_and_b32 v44, 0xffff0000, v44
  v_mul_f32 v44, v44, v45
  v_cvt_pk_bf16_f32 v44, v44, v44
  ds_write_b16 v38, v44
  s_waitcnt lgkmcnt(0)
  ds_read_b64 v[136:137], v39
  s_waitcnt lgkmcnt(0)
  v_mfma_f32_16x16x16_bf16 v[44:47], v[100:101], v[136:137], 0
  v_mfma_f32_16x16x16_bf16 v[48:51], v[102:103], v[136:137], 0
  v_mfma_f32_16x16x16_bf16 v[52:55], v[104:105], v[136:137], 0
  v_mfma_f32_16x16x16_bf16 v[56:59], v[106:107], v[136:137], 0
  s_nop 5
  v_cndmask_b32 v128, v44, v48, s[68:69]
  v_cndmask_b32 v129, v45, v49, s[68:69]
  v_cndmask_b32 v130, v46, v50, s[68:69]
  v_cndmask_b32 v131, v47, v51, s[68:69]
  v_cndmask_b32 v128, v128, v52, s[70:71]
  v_cndmask_b32 v129, v129, v53, s[70:71]
  v_cndmask_b32 v130, v130, v54, s[70:71]
  v_cndmask_b32 v131, v131, v55, s[70:71]
  v_cndmask_b32 v128, v128, v56, s[72:73]
  v_cndmask_b32 v129, v129, v57, s[72:73]
  v_cndmask_b32 v130, v130, v58, s[72:73]
  v_cndmask_b32 v131, v131, v59, s[72:73]
  s_mov_b32 exec_lo, 0xff00ff
  s_mov_b32 exec_hi, 0xff00ff
  v_perm_b32 v128, v128, v7, s64
  v_perm_b32 v129, v129, v7, s65
  v_perm_b32 v130, v130, v7, s66
  v_perm_b32 v131, v131, v7, s67
  buffer_store_dwordx4 v[128:131], v5, s[36:39], s10 offen offset:0 sc1
  s_cmp_lg_u32 s47, 0
  s_cbranch_scc1 L_nodh_36
  s_lshl_b32 s49, s44, 7
  s_lshl_b32 s50, s45, 2
  s_add_u32 s49, s49, s50
  s_add_u32 s49, s49, 405504
  v_mov_b32 v140, 0
  s_mov_b64 exec, 1
  buffer_store_dword v7, v140, s[36:39], s49 offen
L_nodh_36:
  s_mov_b64 exec, -1
L_sdone:
  s_endpgm
L_control:
  s_getreg_b32 s56, hwreg(HW_REG_XCC_ID, 0, 4)
  v_lshrrev_b32 v12, 5, v0
  v_and_b32 v13, 31, v0
  v_lshlrev_b32 v14, 10, v12
  v_lshl_add_u32 v15, v13, 5, v14
  v_lshl_add_u32 v2, v13, 3, v14
  v_lshlrev_b32 v3, 3, v13
  v_lshl_add_u32 v3, v12, 8, v3
  v_add_u32 v100, 116736, v3
  v_mov_b32 v96, 0
  v_mov_b32 v97, 0
  v_mov_b32 v98, 0
  v_mov_b32 v99, 0
  v_lshlrev_b32 v3, 4, v0
  v_mov_b32 v4, 0
  s_lshl_b32 s49, s44, 5
  s_add_u32 s49, s49, s45
  s_lshl_b32 s50, s49, 9
  s_add_u32 s51, s50, 131072
  s_lshl_b32 s52, s58, 8
  v_mov_b32 v16, 0
  v_cmp_gt_u32 vcc, 2, v0
  v_mov_b32 v18, 0xff800000
  s_nop 0
  v_cndmask_b32 v16, v16, v18, vcc
  v_subrev_u32 v19, 8, v0
  v_cmp_gt_u32 vcc, 16, v19
  v_mov_b32 v18, -1.0
  s_nop 0
  v_cndmask_b32 v16, v16, v18, vcc
  v_mov_b32 v17, v16
  v_lshlrev_b32 v18, 3, v0
  v_add_u32 v18, 122880, v18
  s_mov_b32 exec_hi, 0
  ds_write_b64 v18, v[16:17]
  s_mov_b64 exec, -1
  s_waitcnt lgkmcnt(0)
  s_mov_b32 s36, s26
  s_and_b32 s37, s27, 0xffff
  s_mov_b32 s38, 4194304
  s_mov_b32 s39, 0x20000
  s_mov_b32 s32, s24
  s_and_b32 s33, s25, 0xffff
  s_mov_b32 s34, 256
  s_mov_b32 s35, 0x20000
  s_mov_b32 s40, s4
  s_and_b32 s41, s5, 0xffff
  s_mov_b32 s42, 2048
  s_mov_b32 s43, 0x20000
  s_cmp_lg_u32 s2, 0
  s_cbranch_scc1 L_nononce_37
  s_memrealtime s[100:101]
  s_waitcnt lgkmcnt(0)
  s_or_b32 s100, s100, 16
  v_mov_b32 v16, s100
  s_mov_b64 exec, 1
  buffer_store_dword v16, v4, s[32:35], 0 offen sc1
  s_mov_b64 exec, -1
L_nononce_37:
  buffer_load_dwordx2 v[10:11], v2, s[40:43], s52 offen
  v_mov_b32 v1, 0
  buffer_load_dwordx4 v[2:5], v15, s[40:43], 0 offen
  buffer_load_dwordx4 v[6:9], v15, s[40:43], 0 offen offset:16
  v_mov_b32 v109, 0
  s_barrier
  s_barrier
  v_lshlrev_b32 v22, 4, v0
  s_mov_b32 exec_hi, 0
  buffer_store_dwordx4 v[96:99], v22, s[36:39], s51 offen offset:0
  s_mov_b64 exec, -1
  v_lshrrev_b32 v12, 4, v0
  v_and_b32 v13, 1, v0
  v_lshlrev_b32 v14, 8, v13
  v_lshl_add_u32 v14, v12, 4, v14
  v_add_u32 v101, 116736, v14
  v_bfe_u32 v15, v0, 1, 2
  v_lshl_add_u32 v106, v15, 6, v14
  v_bfe_u32 v14, v0, 2, 2
  v_lshl_add_u32 v15, v12, 3, v14
  v_lshlrev_b32 v15, 7, v15
  v_and_b32 v16, 3, v0
  v_lshl_add_u32 v15, v16, 3, v15
  v_lshrrev_b32 v14, 1, v14
  v_and_b32 v16, 1, v12
  v_lshl_add_u32 v14, v16, 1, v14
  v_xor_b32 v16, 0, v14
  v_lshl_add_u32 v102, v16, 5, v15
  v_xor_b32 v16, 1, v14
  v_lshl_add_u32 v103, v16, 5, v15
  v_xor_b32 v16, 2, v14
  v_lshl_add_u32 v104, v16, 5, v15
  v_xor_b32 v16, 3, v14
  v_lshl_add_u32 v105, v16, 5, v15
  v_and_b32 v16, 15, v0
  v_lshlrev_b32 v17, 4, v16
  v_lshl_add_u32 v107, v12, 9, v17
  v_lshrrev_b32 v17, 5, v0
  v_mul_u32_u24 v17, 320, v17
  v_and_b32 v18, 1, v12
  v_lshl_add_u32 v17, v18, 7, v17
  v_lshl_add_u32 v17, v16, 3, v17
  v_add_u32 v108, 118784, v17
  s_mov_b32 s68, 0xc000c
  s_mov_b32 s69, 0xc000c
  s_mov_b32 s70, 0x300030
  s_mov_b32 s71, 0x300030
  s_mov_b32 s72, 0xc000c0
  s_mov_b32 s73, 0xc000c0
  v_mov_b32 v113, 0
  s_waitcnt vmcnt(1)
  buffer_load_dword v114, v1, s[32:35], 0 offen sc1
  v_and_b32 v17, 0xffff0000, v2
  v_lshlrev_b32 v16, 16, v2
  v_and_b32 v19, 0xffff0000, v3
  v_lshlrev_b32 v18, 16, v3
  v_and_b32 v21, 0xffff0000, v4
  v_lshlrev_b32 v20, 16, v4
  v_and_b32 v23, 0xffff0000, v5
  v_lshlrev_b32 v22, 16, v5
  v_and_b32 v25, 0xffff0000, v6
  v_lshlrev_b32 v24, 16, v6
  v_and_b32 v27, 0xffff0000, v7
  v_lshlrev_b32 v26, 16, v7
  v_and_b32 v29, 0xffff0000, v8
  v_lshlrev_b32 v28, 16, v8
  v_and_b32 v31, 0xffff0000, v9
  v_lshlrev_b32 v30, 16, v9
  v_pk_add_f32 v[32:33], v[16:17], v[18:19]
  v_pk_add_f32 v[32:33], v[32:33], v[20:21]
  v_pk_add_f32 v[32:33], v[32:33], v[22:23]
  v_pk_add_f32 v[32:33], v[32:33], v[24:25]
  v_pk_add_f32 v[32:33], v[32:33], v[26:27]
  v_pk_add_f32 v[32:33], v[32:33], v[28:29]
  v_pk_add_f32 v[32:33], v[32:33], v[30:31]
  v_add_f32 v12, v32, v33
  v_mov_b32 v13, v12
  s_nop 1
  v_permlane16_swap_b32 v12, v13
  v_add_f32 v12, v12, v13
  s_nop 1
  v_add_f32_dpp v12, v12, v12 row_ror:8 row_mask:0xf bank_mask:0xf
  s_nop 1
  v_add_f32_dpp v12, v12, v12 row_ror:4 row_mask:0xf bank_mask:0xf
  s_nop 1
  v_add_f32_dpp v12, v12, v12 row_ror:2 row_mask:0xf bank_mask:0xf
  s_nop 1
  v_add_f32_dpp v12, v12, v12 row_ror:1 row_mask:0xf bank_mask:0xf
  v_mul_f32 v13, 0x3b000000, v12
  v_sub_f32 v16, v16, v13
  v_sub_f32 v17, v17, v13
  v_sub_f32 v18, v18, v13
  v_sub_f32 v19, v19, v13
  v_sub_f32 v20, v20, v13
  v_sub_f32 v21, v21, v13
  v_sub_f32 v22, v22, v13
  v_sub_f32 v23, v23, v13
  v_sub_f32 v24, v24, v13
  v_sub_f32 v25, v25, v13
  v_sub_f32 v26, v26, v13
  v_sub_f32 v27, v27, v13
  v_sub_f32 v28, v28, v13
  v_sub_f32 v29, v29, v13
  v_sub_f32 v30, v30, v13
  v_sub_f32 v31, v31, v13
  v_mul_f32 v14, v16, v16
  v_mul_f32 v15, v17, v17
  v_fmac_f32 v14, v18, v18
  v_fmac_f32 v15, v19, v19
  v_fmac_f32 v14, v20, v20
  v_fmac_f32 v15, v21, v21
  v_fmac_f32 v14, v22, v22
  v_fmac_f32 v15, v23, v23
  v_fmac_f32 v14, v24, v24
  v_fmac_f32 v15, v25, v25
  v_fmac_f32 v14, v26, v26
  v_fmac_f32 v15, v27, v27
  v_fmac_f32 v14, v28, v28
  v_fmac_f32 v15, v29, v29
  v_fmac_f32 v14, v30, v30
  v_fmac_f32 v15, v31, v31
  v_add_f32 v14, v14, v15
  v_mov_b32 v15, v14
  s_nop 1
  v_permlane16_swap_b32 v14, v15
  v_add_f32 v14, v14, v15
  s_nop 1
  v_add_f32_dpp v14, v14, v14 row_ror:8 row_mask:0xf bank_mask:0xf
  s_nop 1
  v_add_f32_dpp v14, v14, v14 row_ror:4 row_mask:0xf bank_mask:0xf
  s_nop 1
  v_add_f32_dpp v14, v14, v14 row_ror:2 row_mask:0xf bank_mask:0xf
  s_nop 1
  v_add_f32_dpp v14, v14, v14 row_ror:1 row_mask:0xf bank_mask:0xf
  v_mul_f32 v12, 0x3b000000, v12
  v_mul_f32 v14, 0x3b000000, v14
  v_cvt_pk_bf16_f32 v15, v12, v14
  v_lshlrev_b32 v12, 16, v15
  v_and_b32 v14, 0xffff0000, v15
  v_add_f32 v14, 0x3727c5ac, v14
  v_cvt_pk_bf16_f32 v14, v14, v14
  v_and_b32 v14, 0xffff0000, v14
  v_sqrt_f32 v14, v14
  s_nop 0
  v_cvt_pk_bf16_f32 v14, v14, v14
  v_and_b32 v14, 0xffff0000, v14
  v_rcp_f32 v15, v14
  v_and_b32 v17, 0xffff0000, v10
  v_lshlrev_b32 v16, 16, v10
  v_and_b32 v19, 0xffff0000, v11
  v_lshlrev_b32 v18, 16, v11
  v_sub_f32 v16, v16, v12
  v_sub_f32 v17, v17, v12
  v_sub_f32 v18, v18, v12
  v_sub_f32 v19, v19, v12
  v_cvt_pk_bf16_f32 v24, v16, v17
  v_and_b32 v17, 0xffff0000, v24
  v_lshlrev_b32 v16, 16, v24
  v_cvt_pk_bf16_f32 v24, v18, v19
  v_and_b32 v19, 0xffff0000, v24
  v_lshlrev_b32 v18, 16, v24
  v_mul_f32 v24, v16, v15
  v_mul_f32 v25, v17, v15
  v_mul_f32 v26, v18, v15
  v_mul_f32 v27, v19, v15
  v_fma_f32 v16, -v24, v14, v16
  v_fma_f32 v17, -v25, v14, v17
  v_fma_f32 v18, -v26, v14, v18
  v_fma_f32 v19, -v27, v14, v19
  v_fma_f32 v16, v16, v15, v24
  v_fma_f32 v17, v17, v15, v25
  v_fma_f32 v18, v18, v15, v26
  v_fma_f32 v19, v19, v15, v27
  v_cvt_pk_bf16_f32 v16, v16, v17
  v_cvt_pk_bf16_f32 v17, v18, v19
  ds_write_b64 v100, v[16:17]
  s_waitcnt lgkmcnt(0)
  ds_read_b128 v[64:67], v101 offset:0
  ds_read_b128 v[68:71], v101 offset:64
  ds_read_b128 v[72:75], v101 offset:128
  ds_read_b128 v[76:79], v101 offset:192
  v_mov_b32 v4, 122916
  ds_read_b32 v5, v4
  s_waitcnt lgkmcnt(0)
  v_cmp_ne_u32 vcc, 8, v5
  s_cbranch_vccnz L_retry_38
L_done_40:
  ds_read_b64_tr_b16 v[32:33], v102 offset:0
  ds_read_b64_tr_b16 v[34:35], v102 offset:512
  ds_read_b64_tr_b16 v[36:37], v103 offset:0
  ds_read_b64_tr_b16 v[38:39], v103 offset:512
  ds_read_b64_tr_b16 v[40:41], v104 offset:0
  ds_read_b64_tr_b16 v[42:43], v104 offset:512
  ds_read_b64_tr_b16 v[44:45], v105 offset:0
  ds_read_b64_tr_b16 v[46:47], v105 offset:512
  ds_read_b64_tr_b16 v[48:49], v102 offset:4096
  ds_read_b64_tr_b16 v[50:51], v102 offset:4608
  ds_read_b64_tr_b16 v[52:53], v103 offset:4096
  ds_read_b64_tr_b16 v[54:55], v103 offset:4608
  ds_read_b64_tr_b16 v[56:57], v104 offset:4096
  ds_read_b64_tr_b16 v[58:59], v104 offset:4608
  ds_read_b64_tr_b16 v[60:61], v105 offset:4096
  ds_read_b64_tr_b16 v[62:63], v105 offset:4608
  ds_read_b64_tr_b16 v[116:117], v102 offset:8192
  ds_read_b64_tr_b16 v[118:119], v102 offset:8704
  ds_read_b64_tr_b16 v[120:121], v103 offset:8192
  ds_read_b64_tr_b16 v[122:123], v103 offset:8704
  ds_read_b64_tr_b16 v[124:125], v104 offset:8192
  ds_read_b64_tr_b16 v[126:127], v104 offset:8704
  ds_read_b64_tr_b16 v[128:129], v105 offset:8192
  ds_read_b64_tr_b16 v[130:131], v105 offset:8704
  s_waitcnt lgkmcnt(15)
  v_mfma_f32_16x16x32_bf16 v[80:83], v[32:35], v[64:67], 0
  s_waitcnt lgkmcnt(15)
  v_mfma_f32_16x16x32_bf16 v[84:87], v[36:39], v[64:67], 0
  s_waitcnt lgkmcnt(15)
  v_mfma_f32_16x16x32_bf16 v[88:91], v[40:43], v[64:67], 0
  s_waitcnt lgkmcnt(15)
  v_mfma_f32_16x16x32_bf16 v[92:95], v[44:47], v[64:67], 0
  ds_read_b64_tr_b16 v[16:17], v102 offset:12288
  ds_read_b64_tr_b16 v[18:19], v102 offset:12800
  ds_read_b64_tr_b16 v[20:21], v103 offset:12288
  ds_read_b64_tr_b16 v[22:23], v103 offset:12800
  ds_read_b64_tr_b16 v[24:25], v104 offset:12288
  ds_read_b64_tr_b16 v[26:27], v104 offset:12800
  ds_read_b64_tr_b16 v[28:29], v105 offset:12288
  ds_read_b64_tr_b16 v[30:31], v105 offset:12800
  s_waitcnt lgkmcnt(15)
  v_mfma_f32_16x16x32_bf16 v[80:83], v[48:51], v[68:71], v[80:83]
  s_waitcnt lgkmcnt(15)
  v_mfma_f32_16x16x32_bf16 v[84:87], v[52:55], v[68:71], v[84:87]
  s_waitcnt lgkmcnt(15)
  v_mfma_f32_16x16x32_bf16 v[88:91], v[56:59], v[68:71], v[88:91]
  s_waitcnt lgkmcnt(15)
  v_mfma_f32_16x16x32_bf16 v[92:95], v[60:63], v[68:71], v[92:95]
  s_waitcnt lgkmcnt(14)
  v_mfma_f32_16x16x32_bf16 v[80:83], v[116:119], v[72:75], v[80:83]
  s_waitcnt lgkmcnt(12)
  v_mfma_f32_16x16x32_bf16 v[84:87], v[120:123], v[72:75], v[84:87]
  s_waitcnt lgkmcnt(10)
  v_mfma_f32_16x16x32_bf16 v[88:91], v[124:127], v[72:75], v[88:91]
  s_waitcnt lgkmcnt(8)
  v_mfma_f32_16x16x32_bf16 v[92:95], v[128:131], v[72:75], v[92:95]
  s_waitcnt lgkmcnt(6)
  v_mfma_f32_16x16x32_bf16 v[80:83], v[16:19], v[76:79], v[80:83]
  s_waitcnt lgkmcnt(4)
  v_mfma_f32_16x16x32_bf16 v[84:87], v[20:23], v[76:79], v[84:87]
  s_waitcnt lgkmcnt(2)
  v_mfma_f32_16x16x32_bf16 v[88:91], v[24:27], v[76:79], v[88:91]
  s_waitcnt lgkmcnt(0)
  v_mfma_f32_16x16x32_bf16 v[92:95], v[28:31], v[76:79], v[92:95]
  s_waitcnt vmcnt(1)
  v_or_b32 v109, v109, v113
  v_cmp_ne_u32 vcc, 0, v109
  s_cbranch_vccnz L_have_41
  s_waitcnt vmcnt(0)
  v_mov_b32 v109, v114
  v_cmp_ne_u32 vcc, 0, v109
  s_cbranch_vccnz L_have_41
  buffer_load_dword v109, v1, s[32:35], 0 offen sc1
  s_waitcnt vmcnt(0)
  v_cmp_eq_u32 vcc, 0, v109
  s_cbranch_vccnz L_retry_42
L_done_44:
L_have_41:
  v_readfirstlane_b32 s53, v109
  v_cndmask_b32 v16, v80, v84, s[68:69]
  v_cndmask_b32 v17, v81, v85, s[68:69]
  v_cndmask_b32 v18, v82, v86, s[68:69]
  v_cndmask_b32 v19, v83, v87, s[68:69]
  v_cndmask_b32 v16, v16, v88, s[70:71]
  v_cndmask_b32 v17, v17, v89, s[70:71]
  v_cndmask_b32 v18, v18, v90, s[70:71]
  v_cndmask_b32 v19, v19, v91, s[70:71]
  v_cndmask_b32 v16, v16, v92, s[72:73]
  v_cndmask_b32 v17, v17, v93, s[72:73]
  v_cndmask_b32 v18, v18, v94, s[72:73]
  v_cndmask_b32 v19, v19, v95, s[72:73]
  s_xor_b32 s49, s53, s56
  v_mov_b32 v112, s49
  v_mov_b32 v110, s53
  s_lshl_b32 s50, s44, 5
  s_add_u32 s50, s50, s45
  s_lshl_b32 s50, s50, 9
  s_add_u32 s51, s50, 131072
  s_add_u32 s50, s50, 0
  v_add_u32 v16, 0x80, v16
  v_add_u32 v17, 0x80, v17
  v_add_u32 v18, 0x80, v18
  v_add_u32 v19, 0x80, v19
  v_perm_b32 v16, v16, v112, s64
  v_perm_b32 v17, v17, v112, s65
  v_perm_b32 v18, v18, v112, s66
  v_perm_b32 v19, v19, v112, s67
  s_mov_b32 exec_lo, 0xff00ff
  s_mov_b32 exec_hi, 0xff00ff
  buffer_store_dwordx4 v[16:19], v106, s[36:39], s51 offen
  v_mov_b32 v116, v16
  v_mov_b32 v117, v17
  v_mov_b32 v118, v18
  v_mov_b32 v119, v19
  s_mov_b32 s11, s50
  s_mov_b64 exec, -1
  s_waitcnt vmcnt(0)
  s_lshl_b32 s50, s44, 14
  s_lshl_b32 s51, s57, 8
  s_add_u32 s50, s50, s51
  s_add_u32 s50, s50, 131072
  s_setprio 3
  s_add_u32 s51, s50, 0
  buffer_load_dwordx4 v[32:35], v107, s[36:39], s51 offen offset:0 sc1
  buffer_load_dwordx4 v[36:39], v107, s[36:39], s51 offen offset:2048 sc1
  s_add_u32 s51, s50, 4096
  buffer_load_dwordx4 v[40:43], v107, s[36:39], s51 offen offset:0 sc1
  buffer_load_dwordx4 v[44:47], v107, s[36:39], s51 offen offset:2048 sc1
  s_add_u32 s51, s50, 8192
  buffer_load_dwordx4 v[48:51], v107, s[36:39], s51 offen offset:0 sc1
  buffer_load_dwordx4 v[52:55], v107, s[36:39], s51 offen offset:2048 sc1
  s_add_u32 s51, s50, 12288
  buffer_load_dwordx4 v[56:59], v107, s[36:39], s51 offen offset:0 sc1
  buffer_load_dwordx4 v[60:63], v107, s[36:39], s51 offen offset:2048 sc1
  s_mov_b32 exec_lo, 0xff00ff
  s_mov_b32 exec_hi, 0xff00ff
  buffer_store_dwordx4 v[116:119], v106, s[36:39], s11 offen offset:0 sc1
  s_mov_b64 exec, -1
  s_setprio 0
  s_waitcnt vmcnt(1)
  v_perm_b32 v16, v33, v32, s61
  v_perm_b32 v17, v35, v34, s62
  v_bitop3_b32 v16, v16, v17, v112 bitop3:0x56
  v_mov_b32 v20, v16
  v_perm_b32 v18, v37, v36, s61
  v_perm_b32 v19, v39, v38, s62
  v_bitop3_b32 v18, v18, v19, v112 bitop3:0x56
  v_or_b32 v20, v20, v18
  v_perm_b32 v16, v41, v40, s61
  v_perm_b32 v17, v43, v42, s62
  v_bitop3_b32 v16, v16, v17, v112 bitop3:0x56
  v_or_b32 v20, v20, v16
  v_perm_b32 v18, v45, v44, s61
  v_perm_b32 v19, v47, v46, s62
  v_bitop3_b32 v18, v18, v19, v112 bitop3:0x56
  v_or_b32 v20, v20, v18
  v_perm_b32 v16, v49, v48, s61
  v_perm_b32 v17, v51, v50, s62
  v_bitop3_b32 v16, v16, v17, v112 bitop3:0x56
  v_or_b32 v20, v20, v16
  v_perm_b32 v18, v53, v52, s61
  v_perm_b32 v19, v55, v54, s62
  v_bitop3_b32 v18, v18, v19, v112 bitop3:0x56
  v_or_b32 v20, v20, v18
  v_perm_b32 v16, v57, v56, s61
  v_perm_b32 v17, v59, v58, s62
  v_bitop3_b32 v16, v16, v17, v112 bitop3:0x56
  v_or_b32 v20, v20, v16
  v_perm_b32 v18, v61, v60, s61
  v_perm_b32 v19, v63, v62, s62
  v_bitop3_b32 v18, v18, v19, v112 bitop3:0x56
  v_or_b32 v20, v20, v18
  v_and_b32 v21, 0xfffffff0, v20
  v_cmp_ne_u32 vcc, 0, v21
  s_mov_b32 s55, 8
  s_cbranch_vccz L_qok_45
  s_mov_b64 exec, vcc
  s_mov_b32 s55, 8
L_poll_46:
  s_setprio 3
  s_add_u32 s51, s50, 0
  buffer_load_dwordx4 v[32:35], v107, s[36:39], s51 offen offset:0 sc1
  buffer_load_dwordx4 v[36:39], v107, s[36:39], s51 offen offset:2048 sc1
  s_add_u32 s51, s50, 4096
  buffer_load_dwordx4 v[40:43], v107, s[36:39], s51 offen offset:0 sc1
  buffer_load_dwordx4 v[44:47], v107, s[36:39], s51 offen offset:2048 sc1
  s_add_u32 s51, s50, 8192
  buffer_load_dwordx4 v[48:51], v107, s[36:39], s51 offen offset:0 sc1
  buffer_load_dwordx4 v[52:55], v107, s[36:39], s51 offen offset:2048 sc1
  s_add_u32 s51, s50, 12288
  buffer_load_dwordx4 v[56:59], v107, s[36:39], s51 offen offset:0 sc1
  buffer_load_dwordx4 v[60:63], v107, s[36:39], s51 offen offset:2048 sc1
  s_setprio 0
  s_waitcnt vmcnt(0)
  v_perm_b32 v16, v33, v32, s61
  v_perm_b32 v17, v35, v34, s62
  v_bitop3_b32 v16, v16, v17, v112 bitop3:0x56
  v_mov_b32 v20, v16
  v_perm_b32 v18, v37, v36, s61
  v_perm_b32 v19, v39, v38, s62
  v_bitop3_b32 v18, v18, v19, v112 bitop3:0x56
  v_or_b32 v20, v20, v18
  v_perm_b32 v16, v41, v40, s61
  v_perm_b32 v17, v43, v42, s62
  v_bitop3_b32 v16, v16, v17, v112 bitop3:0x56
  v_or_b32 v20, v20, v16
  v_perm_b32 v18, v45, v44, s61
  v_perm_b32 v19, v47, v46, s62
  v_bitop3_b32 v18, v18, v19, v112 bitop3:0x56
  v_or_b32 v20, v20, v18
  v_perm_b32 v16, v49, v48, s61
  v_perm_b32 v17, v51, v50, s62
  v_bitop3_b32 v16, v16, v17, v112 bitop3:0x56
  v_or_b32 v20, v20, v16
  v_perm_b32 v18, v53, v52, s61
  v_perm_b32 v19, v55, v54, s62
  v_bitop3_b32 v18, v18, v19, v112 bitop3:0x56
  v_or_b32 v20, v20, v18
  v_perm_b32 v16, v57, v56, s61
  v_perm_b32 v17, v59, v58, s62
  v_bitop3_b32 v16, v16, v17, v112 bitop3:0x56
  v_or_b32 v20, v20, v16
  v_perm_b32 v18, v61, v60, s61
  v_perm_b32 v19, v63, v62, s62
  v_bitop3_b32 v18, v18, v19, v112 bitop3:0x56
  v_or_b32 v20, v20, v18
  v_and_b32 v21, 0xfffffff0, v20
  v_cmp_ne_u32 vcc, 0, v21
  s_cbranch_vccz L_qok_45
  s_mov_b64 exec, vcc
  s_sub_u32 s55, s55, 1
  s_cbranch_scc0 L_poll_46
L_done_47:
  s_mov_b64 exec, -1
  s_sub_u32 s50, s50, 131072
  s_mov_b32 s55, 20000
L_poll_48:
  s_setprio 3
  s_add_u32 s51, s50, 0
  buffer_load_dwordx4 v[32:35], v107, s[36:39], s51 offen offset:0 sc1
  buffer_load_dwordx4 v[36:39], v107, s[36:39], s51 offen offset:2048 sc1
  s_add_u32 s51, s50, 4096
  buffer_load_dwordx4 v[40:43], v107, s[36:39], s51 offen offset:0 sc1
  buffer_load_dwordx4 v[44:47], v107, s[36:39], s51 offen offset:2048 sc1
  s_add_u32 s51, s50, 8192
  buffer_load_dwordx4 v[48:51], v107, s[36:39], s51 offen offset:0 sc1
  buffer_load_dwordx4 v[52:55], v107, s[36:39], s51 offen offset:2048 sc1
  s_add_u32 s51, s50, 12288
  buffer_load_dwordx4 v[56:59], v107, s[36:39], s51 offen offset:0 sc1
  buffer_load_dwordx4 v[60:63], v107, s[36:39], s51 offen offset:2048 sc1
  s_setprio 0
  s_waitcnt vmcnt(0)
  v_perm_b32 v16, v33, v32, s61
  v_perm_b32 v17, v35, v34, s62
  v_bitop3_b32 v16, v16, v17, v112 bitop3:0x56
  v_mov_b32 v20, v16
  v_perm_b32 v18, v37, v36, s61
  v_perm_b32 v19, v39, v38, s62
  v_bitop3_b32 v18, v18, v19, v112 bitop3:0x56
  v_or_b32 v20, v20, v18
  v_perm_b32 v16, v41, v40, s61
  v_perm_b32 v17, v43, v42, s62
  v_bitop3_b32 v16, v16, v17, v112 bitop3:0x56
  v_or_b32 v20, v20, v16
  v_perm_b32 v18, v45, v44, s61
  v_perm_b32 v19, v47, v46, s62
  v_bitop3_b32 v18, v18, v19, v112 bitop3:0x56
  v_or_b32 v20, v20, v18
  v_perm_b32 v16, v49, v48, s61
  v_perm_b32 v17, v51, v50, s62
  v_bitop3_b32 v16, v16, v17, v112 bitop3:0x56
  v_or_b32 v20, v20, v16
  v_perm_b32 v18, v53, v52, s61
  v_perm_b32 v19, v55, v54, s62
  v_bitop3_b32 v18, v18, v19, v112 bitop3:0x56
  v_or_b32 v20, v20, v18
  v_perm_b32 v16, v57, v56, s61
  v_perm_b32 v17, v59, v58, s62
  v_bitop3_b32 v16, v16, v17, v112 bitop3:0x56
  v_or_b32 v20, v20, v16
  v_perm_b32 v18, v61, v60, s61
  v_perm_b32 v19, v63, v62, s62
  v_bitop3_b32 v18, v18, v19, v112 bitop3:0x56
  v_or_b32 v20, v20, v18
  v_and_b32 v21, 0xfffffff0, v20
  v_cmp_ne_u32 vcc, 0, v21
  s_cbranch_vccz L_qok_45
  s_mov_b64 exec, vcc
  s_sub_u32 s55, s55, 1
  s_cbranch_scc0 L_poll_48
L_done_49:
L_qok_45:
  s_mov_b64 exec, -1
  v_cmp_ne_u32 vcc, 0, v20
  v_and_b32 v32, 0xffffff00, v32
  v_and_b32 v33, 0xffffff00, v33
  v_and_b32 v34, 0xffffff00, v34
  v_and_b32 v35, 0xffffff00, v35
  v_and_b32 v36, 0xffffff00, v36
  v_and_b32 v37, 0xffffff00, v37
  v_and_b32 v38, 0xffffff00, v38
  v_and_b32 v39, 0xffffff00, v39
  v_and_b32 v40, 0xffffff00, v40
  v_and_b32 v41, 0xffffff00, v41
  v_and_b32 v42, 0xffffff00, v42
  v_and_b32 v43, 0xffffff00, v43
  v_and_b32 v44, 0xffffff00, v44
  v_and_b32 v45, 0xffffff00, v45
  v_and_b32 v46, 0xffffff00, v46
  v_and_b32 v47, 0xffffff00, v47
  v_and_b32 v48, 0xffffff00, v48
  v_and_b32 v49, 0xffffff00, v49
  v_and_b32 v50, 0xffffff00, v50
  v_and_b32 v51, 0xffffff00, v51
  v_and_b32 v52, 0xffffff00, v52
  v_and_b32 v53, 0xffffff00, v53
  v_and_b32 v54, 0xffffff00, v54
  v_and_b32 v55, 0xffffff00, v55
  v_and_b32 v56, 0xffffff00, v56
  v_and_b32 v57, 0xffffff00, v57
  v_and_b32 v58, 0xffffff00, v58
  v_and_b32 v59, 0xffffff00, v59
  v_and_b32 v60, 0xffffff00, v60
  v_and_b32 v61, 0xffffff00, v61
  v_and_b32 v62, 0xffffff00, v62
  v_and_b32 v63, 0xffffff00, v63
  v_pk_add_f32 v[32:33], v[32:33], v[40:41]
  v_pk_add_f32 v[48:49], v[48:49], v[56:57]
  v_pk_add_f32 v[32:33], v[32:33], v[48:49]
  v_pk_add_f32 v[34:35], v[34:35], v[42:43]
  v_pk_add_f32 v[50:51], v[50:51], v[58:59]
  v_pk_add_f32 v[34:35], v[34:35], v[50:51]
  v_pk_add_f32 v[36:37], v[36:37], v[44:45]
  v_pk_add_f32 v[52:53], v[52:53], v[60:61]
  v_pk_add_f32 v[36:37], v[36:37], v[52:53]
  v_pk_add_f32 v[38:39], v[38:39], v[46:47]
  v_pk_add_f32 v[54:55], v[54:55], v[62:63]
  v_pk_add_f32 v[38:39], v[38:39], v[54:55]
  s_cmp_eq_u64 vcc, 0
  s_cselect_b32 s54, 1, 0
  v_cvt_pk_bf16_f32 v16, v32, v33
  v_cvt_pk_bf16_f32 v17, v34, v35
  ds_write_b64 v108, v[16:17] offset:0
  v_cvt_pk_bf16_f32 v18, v36, v37
  v_cvt_pk_bf16_f32 v19, v38, v39
  ds_write_b64 v108, v[18:19] offset:640
  v_mov_b32 v111, s54
  v_mov_b32 v3, 120064
  ds_write_b64 v3, v[110:111]
  s_waitcnt lgkmcnt(0)
  s_barrier
  s_lshl_b32 s49, s44, 5
  s_add_u32 s49, s49, s45
  v_lshlrev_b32 v2, 4, v0
  s_lshl_b32 s50, s49, 11
  s_add_u32 s51, s50, 524288
  buffer_store_dwordx4 v[96:99], v2, s[36:39], s51 offen offset:0
  buffer_store_dwordx4 v[96:99], v2, s[36:39], s51 offen offset:1024
  s_lshl_b32 s50, s49, 7
  s_add_u32 s51, s50, 262144
  s_mov_b64 exec, 0xff
  buffer_store_dwordx4 v[96:99], v2, s[36:39], s51 offen offset:0
  s_mov_b64 exec, -1
  s_lshl_b32 s49, s49, 7
  s_add_u32 s9, s49, 262144
  v_lshrrev_b32 v3, 3, v0
  v_and_b32 v4, 7, v0
  s_cmp_lt_u32 s45, 14
  s_cbranch_scc1 L_cf_50
  s_cmp_ge_u32 s45, 30
  s_cbranch_scc1 L_ci_51
  s_sub_u32 s63, s45, 14
  v_lshlrev_b32 v3, 13, v3
  v_lshl_add_u32 v3, v4, 4, v3
  s_and_b32 s50, s63, 1
  s_lshl_b32 s50, s50, 17
  s_lshl_b32 s51, s44, 3
  s_lshr_b32 s52, s63, 1
  s_add_u32 s51, s51, s52
  s_lshl_b32 s51, s51, 7
  s_add_u32 s50, s50, s51
  s_add_u32 s50, s50, 1048576
  buffer_store_dwordx4 v[96:99], v3, s[36:39], s50 offen offset:0 sc1
  s_add_u32 s50, s50, 65536
  buffer_store_dwordx4 v[96:99], v3, s[36:39], s50 offen offset:0 sc1
  s_lshl_b32 s50, s63, 8
  s_lshl_b32 s51, s44, 12
  s_add_u32 s50, s50, s51
  s_add_u32 s50, s50, 1310720
  s_mov_b64 exec, 0xffff
  buffer_store_dwordx4 v[96:99], v2, s[36:39], s50 offen offset:0
  s_mov_b64 exec, -1
  s_mov_b32 s10, 0
  s_branch L_ce_52
L_cf_50:
  v_mul_u32_u24 v3, 14336, v3
  v_lshl_add_u32 v3, v4, 4, v3
  s_mul_i32 s50, s44, 14
  s_add_u32 s50, s50, s45
  s_lshl_b32 s50, s50, 7
  s_add_u32 s50, s50, 1572864
  buffer_store_dwordx4 v[96:99], v3, s[36:39], s50 offen offset:0 sc1
  s_add_u32 s50, s50, 114688
  buffer_store_dwordx4 v[96:99], v3, s[36:39], s50 offen offset:0 sc1
  s_add_u32 s50, s50, 114688
  buffer_store_dwordx4 v[96:99], v3, s[36:39], s50 offen offset:0 sc1
  s_add_u32 s50, s50, 114688
  buffer_store_dwordx4 v[96:99], v3, s[36:39], s50 offen offset:0 sc1
  s_mov_b32 s10, 1
  s_branch L_ce_52
L_ci_51:
  s_mov_b32 s10, 2
L_ce_52:
  v_and_b32 v3, 3, v0
  v_bfe_u32 v4, v0, 2, 3
  v_lshlrev_b32 v5, 5, v3
  v_lshl_add_u32 v5, v4, 2, v5
  v_add_u32 v6, 124032, v5
  v_add_u32 v5, 123776, v5
  v_lshlrev_b32 v7, 4, v3
  v_mov_b32 v17, v110
  v_mov_b32 v19, v110
  v_mov_b32 v2, 122912
  ds_read_b32 v3, v2
  s_waitcnt lgkmcnt(0)
  v_cmp_ne_u32 vcc, 8, v3
  s_cbranch_vccnz L_retry_53
L_done_55:
  ds_read_b32 v20, v5
  ds_read_b32 v21, v5 offset:128
  s_waitcnt lgkmcnt(1)
  v_mov_b32 v16, v20
  s_nop 1
  v_max_f32_dpp v16, v16, v16 row_ror:4 row_mask:0xf bank_mask:0xf
  s_nop 1
  v_max_f32_dpp v16, v16, v16 row_ror:8 row_mask:0xf bank_mask:0xf
  v_mov_b32 v23, v16
  s_nop 1
  v_permlane16_swap_b32 v16, v23
  v_max_f32 v16, v16, v23
  v_sub_f32 v20, v20, v16
  v_mul_f32 v20, 0x3fb8aa3b, v20
  v_exp_f32 v20, v20
  s_waitcnt lgkmcnt(0)
  s_mov_b32 exec_hi, 0
  ds_write_b32 v6, v20
  s_mov_b64 exec, -1
  v_mul_f32 v18, v20, v21
  s_nop 1
  v_add_f32_dpp v18, v18, v18 row_ror:4 row_mask:0xf bank_mask:0xf
  s_nop 1
  v_add_f32_dpp v18, v18, v18 row_ror:8 row_mask:0xf bank_mask:0xf
  v_mov_b32 v23, v18
  s_nop 1
  v_permlane16_swap_b32 v18, v23
  v_add_f32 v18, v18, v23
  s_mov_b64 exec, 15
  s_cmp_eq_u32 s54, 0
  s_cbranch_scc1 L_st_56
  buffer_store_dwordx4 v[16:19], v7, s[36:39], s9 offen offset:0
L_ste_57:
  s_mov_b64 exec, -1
  s_cmp_eq_u32 s10, 1
  s_cbranch_scc1 L_wv_58
  s_cmp_eq_u32 s10, 2
  s_cbranch_scc1 L_wv_59
  s_waitcnt vmcnt(5)
  s_branch L_wv_60
L_wv_58:
  s_waitcnt vmcnt(6)
  s_branch L_wv_60
L_wv_59:
  s_waitcnt vmcnt(2)
L_wv_60:
  v_and_b32 v2, 31, v0
  v_lshlrev_b32 v3, 7, v2
  v_lshlrev_b32 v2, 2, v2
  v_add_u32 v2, 122944, v2
  s_lshl_b32 s49, s44, 12
  s_lshr_b32 s50, s63, 2
  s_lshl_b32 s50, s50, 4
  s_add_u32 s49, s49, s50
  s_add_u32 s49, s49, 262144
  s_waitcnt lgkmcnt(0)
  s_barrier
  s_cmp_lg_u32 s10, 0
  s_cbranch_scc1 L_cdone_wait
  buffer_load_dwordx4 v[16:19], v3, s[36:39], s49 offen offset:0 sc1
  s_waitcnt vmcnt(0)
  v_xor_b32 v20, v17, v110
  v_bitop3_b32 v20, v20, v19, v110 bitop3:0xf6
  v_cmp_ne_u32 vcc, 0, v20
  s_cbranch_vccnz L_retry_61
L_done_63:
  v_mov_b32 v20, v16
  s_nop 1
  v_max_f32_dpp v20, v20, v20 row_ror:8 row_mask:0xf bank_mask:0xf
  s_nop 1
  v_max_f32_dpp v20, v20, v20 row_ror:4 row_mask:0xf bank_mask:0xf
  s_nop 1
  v_max_f32_dpp v20, v20, v20 row_ror:2 row_mask:0xf bank_mask:0xf
  s_nop 1
  v_max_f32_dpp v20, v20, v20 row_ror:1 row_mask:0xf bank_mask:0xf
  v_sub_f32 v20, v16, v20
  v_mul_f32 v20, 0x3fb8aa3b, v20
  v_exp_f32 v20, v20
  s_nop 0
  v_mul_f32 v21, v20, v18
  s_nop 1
  v_add_f32_dpp v21, v21, v21 row_ror:8 row_mask:0xf bank_mask:0xf
  s_nop 1
  v_add_f32_dpp v21, v21, v21 row_ror:4 row_mask:0xf bank_mask:0xf
  s_nop 1
  v_add_f32_dpp v21, v21, v21 row_ror:2 row_mask:0xf bank_mask:0xf
  s_nop 1
  v_add_f32_dpp v21, v21, v21 row_ror:1 row_mask:0xf bank_mask:0xf
  v_rcp_f32 v21, v21
  s_nop 0
  v_mul_f32 v20, v20, v21
  s_mov_b32 exec_hi, 0
  ds_write_b32 v2, v20
  s_mov_b64 exec, -1
  s_waitcnt lgkmcnt(0)
  s_branch L_cdone
L_cdone_wait:
  v_and_b32 v2, 31, v0
  v_lshlrev_b32 v2, 11, v2
  s_lshl_b32 s49, s44, 16
  s_add_u32 s49, s49, 524288
  buffer_load_dwordx4 v[16:19], v2, s[36:39], s49 offen offset:0 sc1
  s_waitcnt vmcnt(0)
  v_perm_b32 v20, v17, v16, s61
  v_perm_b32 v21, v19, v18, s62
  v_bitop3_b32 v20, v20, v21, v110 bitop3:0x56
  v_cmp_ne_u32 vcc, 0, v20
  s_cbranch_vccnz L_retry_64
L_done_66:
  s_sub_u32 s50, s45, 16
  s_cmp_lt_u32 s45, 14
  s_cselect_b32 s50, s45, s50
  s_lshl_b32 s50, s50, 5
  s_mul_i32 s52, s44, 448
  s_and_b32 s52, s52, 0xffffff80
  s_mov_b32 s28, s16
  s_and_b32 s29, s17, 0xffff
  s_mov_b32 s30, 1835008
  s_mov_b32 s31, 0x20000
  s_mov_b32 s40, s18
  s_and_b32 s41, s19, 0xffff
  s_mov_b32 s42, 1835008
  s_mov_b32 s43, 0x20000
  v_lshrrev_b32 v4, 2, v0
  v_add_u32 v4, s50, v4
  v_mul_u32_u24 v4, 3584, v4
  v_and_b32 v5, 3, v0
  v_lshl_add_u32 v4, v5, 7, v4
  s_add_u32 s51, s52, 57344
  buffer_load_dword v126, v4, s[28:31], s52 offen
  buffer_load_dword v127, v4, s[28:31], s51 offen
  buffer_load_dword v126, v4, s[40:43], s52 offen
  buffer_load_dword v127, v4, s[40:43], s51 offen
  v_mov_b32 v2, 122924
  v_mov_b32 v3, 1
  ds_write_b32 v2, v3
  s_waitcnt vmcnt(0)
  s_waitcnt lgkmcnt(0)
L_cdone:
  s_endpgm
L_st_8:
  buffer_store_dwordx4 v[16:19], v157, s[36:39], s6 offen offset:0 sc1
  s_branch L_ste_9
L_retry_10:
  s_mov_b32 s55, 20000
L_poll_11:
  s_mov_b64 exec, vcc
  buffer_load_dwordx4 v[40:43], v158, s[36:39], s7 offen offset:0 sc1
  ds_read_b32 v144, v159
  s_waitcnt vmcnt(0)
  s_waitcnt lgkmcnt(0)
  v_perm_b32 v140, v41, v40, s61
  v_perm_b32 v141, v43, v42, s62
  v_bitop3_b32 v140, v140, v141, v7 bitop3:0x56
  v_cmp_ne_u32 vcc, 0, v140
  s_cbranch_vccz L_retry_10_ok
  s_sub_u32 s55, s55, 1
  s_cbranch_scc0 L_poll_11
L_retry_10_ok:
  s_mov_b64 exec, -1
  s_branch L_done_12
L_wretry_14:
  s_mov_b32 s55, 200000
L_wretry_14_l:
  ds_read_b32 v144, v159
  s_waitcnt lgkmcnt(0)
  v_cmp_gt_f32 vcc, 0, v144
  s_cbranch_vccz L_wok_13
  s_sub_u32 s55, s55, 1
  s_cbranch_scc0 L_wretry_14_l
  s_branch L_wok_13
L_st_19:
  buffer_store_dwordx2 v[140:141], v32, s[36:39], s10 offen offset:0 sc1
  s_branch L_ste_20
L_retry_21:
  s_mov_b32 s55, 60
L_poll_22:
  s_mov_b64 exec, vcc
  buffer_load_dword v10, v9, s[36:39], s49 offen offset:0 sc1
  s_waitcnt vmcnt(0)
  v_cmp_ne_u32 vcc, v10, v7
  s_cbranch_vccz L_retry_21_ok
  s_sub_u32 s55, s55, 1
  s_cbranch_scc0 L_poll_22
L_retry_21_ok:
  s_mov_b64 exec, -1
  s_branch L_done_23
L_retry_30:
  s_mov_b32 s55, 400000
L_poll_31:
  ds_read_b32 v11, v10
  s_waitcnt lgkmcnt(0)
  v_cmp_eq_u32 vcc, 0, v11
  s_cbranch_vccz L_retry_30_ok
  s_sub_u32 s55, s55, 1
  s_cbranch_scc0 L_poll_31
L_retry_30_ok:
  s_branch L_done_32
L_retry_33:
  s_mov_b32 s55, 20000
L_poll_34:
  s_mov_b64 exec, vcc
  buffer_load_dwordx4 v[40:43], v30, s[36:39], s9 offen offset:0 sc1
  s_waitcnt vmcnt(0)
  v_xor_b32 v140, v41, v7
  v_bitop3_b32 v140, v140, v43, v7 bitop3:0xf6
  v_cmp_ne_u32 vcc, 0, v140
  s_cbranch_vccz L_retry_33_ok
  s_sub_u32 s55, s55, 1
  s_cbranch_scc0 L_poll_34
L_retry_33_ok:
  s_mov_b64 exec, -1
  s_branch L_done_35
L_retry_38:
  s_mov_b32 s55, 200000
L_poll_39:
  ds_read_b32 v5, v4
  s_waitcnt lgkmcnt(0)
  v_cmp_ne_u32 vcc, 8, v5
  s_cbranch_vccz L_retry_38_ok
  s_sub_u32 s55, s55, 1
  s_cbranch_scc0 L_poll_39
L_retry_38_ok:
  s_branch L_done_40
L_retry_42:
  s_mov_b32 s55, 20000
L_poll_43:
  buffer_load_dword v109, v1, s[32:35], 0 offen sc1
  s_waitcnt vmcnt(0)
  v_cmp_eq_u32 vcc, 0, v109
  s_cbranch_vccz L_retry_42_ok
  s_sub_u32 s55, s55, 1
  s_cbranch_scc0 L_poll_43
L_retry_42_ok:
  s_branch L_done_44
L_retry_53:
  s_mov_b32 s55, 200000
L_poll_54:
  ds_read_b32 v3, v2
  s_waitcnt lgkmcnt(0)
  v_cmp_ne_u32 vcc, 8, v3
  s_cbranch_vccz L_retry_53_ok
  s_sub_u32 s55, s55, 1
  s_cbranch_scc0 L_poll_54
L_retry_53_ok:
  s_branch L_done_55
L_st_56:
  buffer_store_dwordx4 v[16:19], v7, s[36:39], s9 offen offset:0 sc1
  s_branch L_ste_57
L_retry_61:
  s_mov_b32 s55, 20000
L_poll_62:
  s_mov_b64 exec, vcc
  buffer_load_dwordx4 v[16:19], v3, s[36:39], s49 offen offset:0 sc1
  s_waitcnt vmcnt(0)
  v_xor_b32 v20, v17, v110
  v_bitop3_b32 v20, v20, v19, v110 bitop3:0xf6
  v_cmp_ne_u32 vcc, 0, v20
  s_cbranch_vccz L_retry_61_ok
  s_sub_u32 s55, s55, 1
  s_cbranch_scc0 L_poll_62
L_retry_61_ok:
  s_mov_b64 exec, -1
  s_branch L_done_63
L_retry_64:
  s_mov_b32 s55, 40
L_poll_65:
  s_mov_b64 exec, vcc
  buffer_load_dwordx4 v[16:19], v2, s[36:39], s49 offen offset:0 sc1
  s_waitcnt vmcnt(0)
  v_perm_b32 v20, v17, v16, s61
  v_perm_b32 v21, v19, v18, s62
  v_bitop3_b32 v20, v20, v21, v110 bitop3:0x56
  v_cmp_ne_u32 vcc, 0, v20
  s_cbranch_vccz L_retry_64_ok
  s_sub_u32 s55, s55, 1
  s_cbranch_scc0 L_poll_65
L_retry_64_ok:
  s_mov_b64 exec, -1
  s_branch L_done_66
L_exit:
  s_endpgm
.section .rodata,"a"
.p2align 6
.amdhsa_kernel sequential_preLN__sliding_block_cached__swiglu_ffn__decode_kernel
  .amdhsa_next_free_vgpr 160
  .amdhsa_next_free_sgpr 102
  .amdhsa_accum_offset 160
  .amdhsa_group_segment_fixed_size 0
  .amdhsa_kernarg_size 96
  .amdhsa_user_sgpr_count 2
  .amdhsa_user_sgpr_kernarg_segment_ptr 1
  .amdhsa_system_sgpr_workgroup_id_x 1
  .amdhsa_float_denorm_mode_32 3
.end_amdhsa_kernel
```
